```python
import torch

def _softmax(x, axis=-1):
    return torch.softmax(x, dim=axis)
def _gelu(x):
    return torch.nn.functional.gelu(x, approximate="tanh")
def _silu(x):
    return torch.nn.functional.silu(x)
def _sigmoid(x):
    return torch.sigmoid(x)
def _layernorm(x, axis=-1, eps=1e-5):
    m = x.mean(dim=axis, keepdim=True)
    v = x.var(dim=axis, keepdim=True, unbiased=False)
    return (x - m) / torch.sqrt(v + eps)
def _scatter_add(tgt, idx, src, axis=0):
    return tgt.clone().index_add_(axis, idx, src)
def _segment_sum(src, seg, n):
    out = torch.zeros((n,) + src.shape[1:], dtype=src.dtype)
    return out.index_add_(0, seg, src)
def _pad(x, pw):
    flat = tuple(v for pair in reversed(pw) for v in pair)
    return torch.nn.functional.pad(x, flat)

kernel_name = 'recurrent_scan__sliding_block_cached__dense_activation_squared_relu__decode'

def setup_inputs():

    _w = (lambda a: (lambda t: t.to(torch.bfloat16) if t.is_floating_point() else t)(torch.as_tensor(a)))
    def _A_setup():
        B, Sq, D = 2, 1, 512
        Hq, Hkv, Sk, Dh = 32, 8, 32768, 128
        assert Hq % Hkv == 0, (Hq, Hkv)
        return {
            "x": _w((lambda *s: torch.randn(*s, dtype=torch.bfloat16) * 0.05)(B, Sq, D)),
            "k_cache": _w((lambda *s: torch.randn(*s, dtype=torch.bfloat16) * 1.6)(B, Hkv, Sk, Dh)),
            "v_cache": _w((lambda *s: torch.randn(*s, dtype=torch.bfloat16) * 0.2)(B, Hkv, Sk, Dh)),
            "wq": _w((lambda *s: torch.randn(*s, dtype=torch.bfloat16) * 1.6)(D, Hq * Dh) * (D ** -0.5)),
            "wo": _w((lambda *s: torch.randn(*s, dtype=torch.bfloat16) * 0.2)(Hq * Dh, D) * ((Hq * Dh) ** -0.5)),
        }
    _A_in = _A_setup()

    def _B_setup():
        B, S, D, F = 2, 1, 512, 1792
        return {
            "x": _w((lambda *s: torch.randn(*s, dtype=torch.bfloat16) * 0.05)(B, S, D)),
            "w1": _w((lambda *s: torch.randn(*s, dtype=torch.bfloat16) * 0.1)(D, F)),
            "b1": _w((lambda *s: torch.randn(*s, dtype=torch.bfloat16) * 0.8)(F)),
            "w2": _w((lambda *s: torch.randn(*s, dtype=torch.bfloat16) * 0.1)(F, D)),
            "b2": _w((lambda *s: torch.randn(*s, dtype=torch.bfloat16) * 12.8)(D)),
        }
    _B_in = _B_setup()

    return {
        "A_x": _A_in["x"],
        "A_k_cache": _A_in["k_cache"],
        "A_v_cache": _A_in["v_cache"],
        "A_wq": _A_in["wq"],
        "A_wo": _A_in["wo"],
        "B_x": _B_in["x"],
        "B_w1": _B_in["w1"],
        "B_b1": _B_in["b1"],
        "B_w2": _B_in["w2"],
        "B_b2": _B_in["b2"],
    }

def reference(A_x, A_k_cache, A_v_cache, A_wq, A_wo, B_x, B_w1, B_b1, B_w2, B_b2):
    def _A_ref(x, k_cache, v_cache, wq, wo):
        B, Sq, D = x.shape
        Hq, Dh = 32, 128
        Hkv, Sk = k_cache.shape[1], k_cache.shape[2]
        W = min(4096, max(256, Sk // 4))
        rep = Hq // Hkv
        q = (lambda x, *d: x.permute(*d))((x @ wq).reshape(B, Sq, Hq, Dh), 0, 2, 1, 3)
        k = (lambda x, n, axis: torch.repeat_interleave(x, n, dim=axis))(k_cache[:, :, Sk - W:, :], rep, axis=1)
        v = (lambda x, n, axis: torch.repeat_interleave(x, n, dim=axis))(v_cache[:, :, Sk - W:, :], rep, axis=1)
        scores = torch.einsum("bhqd,bhkd->bhqk", q, k) * (Dh ** -0.5)
        p = _softmax(scores, axis=-1)
        o = torch.einsum("bhqk,bhkd->bhqd", p, v)
        return (lambda x, *d: x.permute(*d))(o, 0, 2, 1, 3).reshape(B, Sq, Hq * Dh) @ wo

    def _B_ref(x, w1, b1, w2, b2):
        h = torch.einsum("bsd,df->bsf", x, w1) + b1
        zero = torch.zeros_like(h)
        r = torch.where(h > zero, h, zero)
        h = r * r
        out = torch.einsum("bsf,fd->bsd", h, w2) + b2
        return out

    x = A_x
    xn = _layernorm(x, axis=-1)
    s = _A_ref(xn, A_k_cache, A_v_cache, A_wq, A_wo)
    g = _silu(_B_ref(xn, B_w1, B_b1, B_w2, B_b2))
    return x + s * g
```

```asm
; @launch grid=(256,1,1) block=(640,1,1) lds=153040
.amdgcn_target "amdgcn-amd-amdhsa--gfx950"
.text
.globl recurrent_scan__sliding_block_cached__dense_activation_squared_relu__decode_kernel
.p2align 8
.type recurrent_scan__sliding_block_cached__dense_activation_squared_relu__decode_kernel,@function
recurrent_scan__sliding_block_cached__dense_activation_squared_relu__decode_kernel:
    s_load_dwordx16 s[4:19], s[0:1], 0
    s_load_dwordx8 s[20:27], s[0:1], 64
    s_load_dwordx2 s[28:29], s[0:1], 96
    v_readfirstlane_b32 s30, v0
    s_cmpk_ge_u32 s2, 0x100
    s_cbranch_scc1 L_end
    v_and_b32 v0, 63, v0
    s_and_b32 s31, s2, 7
    s_lshr_b32 s32, s2, 3
    s_cmpk_ge_u32 s30, 0x100
    s_cbranch_scc1 L_notloader
    v_lshrrev_b32 v12, 3, v0
    s_lshl_b32 s64, s30, 4
    s_getpc_b64 s[48:49]
    v_lshl_add_u32 v13, v12, 7, s64
    global_load_dword v166, v13, s[48:49]
    v_and_b32 v13, 7, v0
    v_and_b32 v14, 2, v12
    v_xor_b32 v13, v13, v14
    v_lshlrev_b32 v13, 4, v13
    s_and_b32 s63, s30, 64
    v_xor_b32 v13, s63, v13
    v_lshl_add_u32 v10, v12, 13, v13
    s_lshr_b32 s45, s2, 6
    s_lshl_b32 s45, s45, 20
    s_and_b32 s46, s32, 7
    s_lshl3_add_u32 s46, s31, s46
    s_lshl_b32 s46, s46, 7
    s_add_u32 s45, s45, s46
    s_mov_b32 s58, 1040512
    s_mov_b32 s59, 0x20000
    s_lshl4_add_u32 m0, s30, 131072
    s_lshl_b32 s47, s30, 10
    s_waitcnt lgkmcnt(0)
    s_add_u32 s56, s10, s45
    s_addc_u32 s57, s11, 0

L_ldA:
    buffer_load_dwordx4 v10, s[56:59], s47 offen nt lds
    s_addk_i32 m0, 0x1000
    s_add_u32 s47, s47, 0x40000
    s_bitcmp0_b32 s47, 20
    s_cbranch_scc1 L_ldA

    s_branch L_ld2

    .p2align 8

L_notloader:
    v_mov_b32 v1, 152704
    v_mov_b32 v5, 0
    v_lshl_add_u32 v6, v0, 2, v1
    ds_write_b32 v6, v5
    s_lshr_b32 s30, s30, 6

    s_cmp_eq_u32 s30, 9
    s_cbranch_scc0 L_nopf
    s_getpc_b64 s[46:47]
L_pc:
    s_mul_i32 s45, s32, 2
    s_add_u32 s45, s45, 30
    v_min_u32 v5, 1, v0
    v_add_u32 v5, s45, v5
    v_lshlrev_b32 v5, 7, v5
    v_min_u32 v5, L_codeend-L_pc-4, v5
    global_load_dword v166, v5, s[46:47]
L_nopf:
    v_lshlrev_b32 v5, 5, v0
    s_cmp_ge_u32 s30, 6
    s_waitcnt lgkmcnt(0)
    s_load_dwordx2 s[34:35], s[28:29], 0
    s_cbranch_scc1 L_nox
    global_load_dwordx4 v[8:11], v5, s[4:5]
    global_load_dwordx4 v[12:15], v5, s[4:5] offset:16
L_nox:
    s_barrier
    s_branch L_nl2

L_ld2:
    s_mul_i32 s44, s2, 5
    s_bfe_u32 s42, s44, 0x20002
    v_and_b32 v2, 15, v0
    v_lshrrev_b32 v3, 4, v0
    s_add_u32 s62, s42, 3
    s_and_b32 s62, s62, 3
    s_add_u32 s62, s62, 4
    s_lshl_b32 s62, s62, 14
    v_mov_b32 v1, 152704
    s_lshr_b32 s45, s30, 4
    s_add_u32 s45, s45, 152768
    v_lshl_add_u32 v16, v0, 2, v1
    v_add_u32 v16, 80, v16
    v_writelane_b32 v16, s45, 0
    v_mov_b32 v15, 0

    s_setprio 3

    s_barrier

    s_add_u32 s67, s31, 7
    s_and_b32 s67, s67, 7
    s_cmp_lt_u32 s67, 7
    s_cbranch_scc0 L_ld_noB
    s_add_u32 m0, s62, s64
    s_and_b32 s65, s32, 15
    s_lshl4_add_u32 s65, s67, s65
    s_cmp_lt_u32 s32, 16
    s_cbranch_scc0 L_ld_w2
    s_and_b32 s45, s65, 3
    s_mul_i32 s45, s45, 458752
    s_lshr_b32 s46, s65, 2
    s_lshl_b32 s46, s46, 7
    s_add_u32 s45, s45, s46
    s_add_u32 s56, s16, s45
    s_addc_u32 s57, s17, 0
    v_mul_u32_u24 v10, 3584, v12
    v_add_u32 v10, v10, v13
    s_mul_i32 s47, s64, 28
    s_mov_b32 s46, 114688
    s_branch L_ld_B
L_ld_w2:
    s_lshr_b32 s45, s65, 3
    s_lshl_b32 s45, s45, 17
    s_and_b32 s46, s65, 7
    s_lshl_b32 s46, s46, 7
    s_add_u32 s45, s45, s46
    s_add_u32 s56, s20, s45
    s_addc_u32 s57, s21, 0
    v_lshl_add_u32 v10, v12, 10, v13
    s_lshl_b32 s47, s64, 3
    s_mov_b32 s46, 0x8000
L_ld_B:
    s_sub_u32 s58, 1835008, s45
    s_mov_b32 s60, 0
L_ldB:
    s_waitcnt vmcnt(4)
    buffer_load_dwordx4 v10, s[56:59], s47 offen nt lds
    s_addk_i32 m0, 0x1000
    s_add_u32 s47, s47, s46
    ds_write_b32 v16, v15
    v_add_u32 v15, 1, v15
    s_add_u32 s60, s60, 1
    s_cmp_lt_u32 s60, 4
    s_cbranch_scc1 L_ldB
L_ld_noB:

    v_lshlrev_b32 v14, 8, v3
    v_xor_b32 v17, v3, v2
    v_lshl_add_u32 v4, v17, 4, v14
    v_xor_b32 v4, s30, v4
    s_lshr_b32 s45, s32, 4
    s_lshl_b32 s45, s45, 26
    s_lshl_b32 s46, s31, 23
    s_add_u32 s45, s45, s46
    s_and_b32 s46, s32, 15
    s_lshl_b32 s46, s46, 16
    s_add_u32 s45, s45, s46
    s_add_u32 s45, s45, 7340032
    s_mov_b32 s50, 0x10000
    s_mov_b32 s51, 0x20000
    s_add_u32 s48, s6, s45
    s_addc_u32 s49, s7, 0
    s_mov_b32 s60, 0
    s_and_b32 s61, s44, 3
L_ldK:
    s_lshr_b32 s47, s60, 2
    s_add_u32 s47, s47, s42
    s_and_b32 s47, s47, 3
    s_add_u32 s62, s61, s60
    s_and_b32 s62, s62, 3
    s_lshl2_add_u32 s47, s47, s62
    s_lshl_b32 s47, s47, 12
    s_add_u32 s47, s47, s64
    s_mov_b32 m0, s47
    s_add_u32 s60, s60, 1
    s_waitcnt vmcnt(4)
    buffer_load_dwordx4 v4, s[48:51], s47 offen nt lds
    ds_write_b32 v16, v15
    v_add_u32 v15, 1, v15
    s_cmp_lt_u32 s60, 16
    s_cbranch_scc1 L_ldK

    v_lshlrev_b32 v17, 1, v3
    v_xor_b32 v17, v17, v2
    v_lshl_add_u32 v8, v17, 4, v14
    s_lshl_b32 s63, s63, 1
    v_xor_b32 v8, s63, v8
    v_lshlrev_b32 v14, 10, v3
    v_lshl_add_u32 v10, v17, 4, v14
    s_and_b32 s63, s30, 0x80
    v_xor_b32 v10, s63, v10
    s_add_u32 s52, s8, s45
    s_addc_u32 s53, s9, 0
    s_mov_b32 s54, 0x10000
    s_mov_b32 s55, 0x20000
    s_mov_b32 s60, 0
    s_and_b32 s61, s44, 3

L_ldV1:
    s_lshr_b32 s47, s60, 2
    s_add_u32 s47, s47, s42
    s_and_b32 s47, s47, 3
    s_add_u32 s62, s61, s60
    s_and_b32 s62, s62, 3
    s_lshl2_add_u32 s47, s47, s62
    s_lshl_b32 s47, s47, 12
    s_add_u32 s47, s47, s64
    s_add_u32 m0, s47, 65536
    s_add_u32 s60, s60, 1
    s_waitcnt vmcnt(4)
    buffer_load_dwordx4 v8, s[52:55], s47 offen nt lds
    ds_write_b32 v16, v15
    v_add_u32 v15, 1, v15
    s_cmp_lt_u32 s60, 12
    s_cbranch_scc1 L_ldV1

    s_lshl_b32 s45, s31, 19
    s_lshr_b32 s46, s32, 2
    s_lshl_b32 s46, s46, 14
    s_add_u32 s45, s45, s46
    s_and_b32 s46, s32, 3
    s_lshl_b32 s46, s46, 8
    s_add_u32 s45, s45, s46
    s_add_u32 s56, s12, s45
    s_addc_u32 s57, s13, 0
    s_mov_b32 s58, 408832

L_sp_1:

    ds_read_b32 v17, v1 offset:16

    s_waitcnt lgkmcnt(0)
    v_cmp_le_u32 vcc, 2, v17
    s_cbranch_vccz L_sp_1
L_ldV2:
    s_lshr_b32 s47, s60, 2
    s_add_u32 s47, s47, s42
    s_and_b32 s47, s47, 3
    s_add_u32 s62, s61, s60
    s_and_b32 s62, s62, 3
    s_lshl2_add_u32 s47, s47, s62
    s_lshl_b32 s47, s47, 12
    s_add_u32 s47, s47, s64
    s_add_u32 m0, s47, 65536
    s_add_u32 s60, s60, 1
    s_waitcnt vmcnt(4)
    buffer_load_dwordx4 v8, s[52:55], s47 offen nt lds
    ds_write_b32 v16, v15
    v_add_u32 v15, 1, v15
    s_cmp_lt_u32 s60, 16
    s_cbranch_scc1 L_ldV2

    s_add_u32 m0, s64, 131072
    s_lshl_b32 s47, s64, 2
    s_add_u32 s47, s47, 0
L_ldWO2:
    s_waitcnt vmcnt(4)
    buffer_load_dwordx4 v10, s[56:59], s47 offen nt lds
    s_addk_i32 m0, 0x1000
    s_add_u32 s47, s47, 0x20000
    ds_write_b32 v16, v15
    v_add_u32 v15, 1, v15
    s_cmp_lt_u32 s47, 524288
    s_cbranch_scc1 L_ldWO2
    s_waitcnt vmcnt(4)
    ds_write_b32 v16, v15
    v_add_u32 v15, 1, v15
    s_waitcnt vmcnt(3)
    ds_write_b32 v16, v15
    v_add_u32 v15, 1, v15
    s_waitcnt vmcnt(2)
    ds_write_b32 v16, v15
    v_add_u32 v15, 1, v15
    s_waitcnt vmcnt(1)
    ds_write_b32 v16, v15
    v_add_u32 v15, 1, v15
    s_waitcnt vmcnt(0)
    ds_write_b32 v16, v15
    v_add_u32 v15, 1, v15
    s_endpgm
L_nl2:

    s_setprio 1
    v_and_b32 v2, 15, v0
    v_lshrrev_b32 v3, 4, v0
    s_mul_i32 s44, s2, 5
    s_bfe_u32 s42, s44, 0x20002
    s_lshl_b32 s41, s31, 5
    s_add_u32 s41, s41, s32
    s_mov_b32 s43, 1000002
    s_add_u32 s68, s31, 7
    s_and_b32 s68, s68, 7
    s_cmp_lt_u32 s68, 7
    s_cselect_b32 s71, 24, 20
    s_mov_b32 s70, s71
    v_mov_b32 v4, 2047
    s_mov_b32 s36, s28
    s_mov_b32 s37, s29
    s_mov_b32 s38, 2097152
    s_mov_b32 s39, 0x20000
    s_mov_b32 s72, 0
    s_mov_b32 s73, 786432
    s_cmp_ge_u32 s30, 6
    s_cbranch_scc1 L_compute

    s_cmp_eq_u32 s30, 4
    s_cbranch_scc0 L_roleB
    s_mov_b32 s44, 0
    s_lshr_b32 s53, s32, 3
    s_lshl_b32 s52, s41, 9
    s_add_u32 s52, s52, 65536
    s_mov_b32 s54, 131072
    s_mov_b32 s55, 151552
    s_mov_b32 s45, 4
    s_branch L_tilecommon
L_roleB:
    s_add_u32 s54, s42, 3
    s_and_b32 s54, s54, 3
    s_add_u32 s54, s54, 4
    s_lshl_b32 s54, s54, 14
    s_mov_b32 s55, 152128
    s_mov_b32 s45, 8
    s_and_b32 s52, s32, 15
    s_lshl4_add_u32 s52, s68, s52
    s_lshr_b32 s44, s32, 4
    s_and_b32 s53, s52, 3
    s_lshr_b32 s46, s52, 3
    s_lshl_b32 s52, s52, 9
    s_cmp_eq_u32 s44, 0
    s_cselect_b32 s53, s53, s46
    s_mov_b32 s46, 1835008
    s_cselect_b32 s46, 196608, s46
    s_add_u32 s52, s52, s46
    s_cmp_eq_u32 s68, 7
    s_cselect_b32 s44, 2, s44
L_tilecommon:

    v_lshrrev_b32 v5, 2, v2
    v_lshl_add_u32 v5, v3, 3, v5
    v_lshlrev_b32 v5, 7, v5
    v_and_b32 v6, 3, v2
    v_lshl_add_u32 v5, v6, 3, v5
    v_add_u32 v5, s54, v5
    v_lshrrev_b32 v6, 3, v2
    v_and_b32 v7, 1, v3
    v_lshl_or_b32 v6, v7, 1, v6

    v_xor_b32 v7, 0, v6
    v_lshl_add_u32 v16, v7, 5, v5
    v_xor_b32 v7, 1, v6
    v_lshl_add_u32 v17, v7, 5, v5
    v_xor_b32 v7, 2, v6
    v_lshl_add_u32 v18, v7, 5, v5
    v_xor_b32 v7, 3, v6
    v_lshl_add_u32 v19, v7, 5, v5
    v_and_b32 v5, 1, v0
    v_mul_u32_u24 v5, 288, v5
    v_lshl_add_u32 v5, v3, 4, v5
    v_add_u32 v20, s55, v5
    v_mov_b32 v21, 1
    v_mov_b32 v60, 0
    s_waitcnt lgkmcnt(0)

    s_add_u32 s34, s34, 0x01401801
    s_addc_u32 s35, s35, 14
    s_lshr_b32 s33, s34, 11
    s_lshr_b64 s[46:47], s[34:35], 22
    s_mov_b32 s40, s46
    s_lshr_b32 s79, s35, 1

    s_cmp_eq_u32 s44, 0
    s_waitcnt vmcnt(0)
    s_cbranch_scc0 L_noLN

    v_lshlrev_b32 v24, 16, v8
    v_and_b32 v25, 0xffff0000, v8
    v_lshlrev_b32 v26, 16, v9
    v_and_b32 v27, 0xffff0000, v9
    v_lshlrev_b32 v28, 16, v10
    v_and_b32 v29, 0xffff0000, v10
    v_lshlrev_b32 v30, 16, v11
    v_and_b32 v31, 0xffff0000, v11
    v_lshlrev_b32 v32, 16, v12
    v_and_b32 v33, 0xffff0000, v12
    v_lshlrev_b32 v34, 16, v13
    v_and_b32 v35, 0xffff0000, v13
    v_lshlrev_b32 v36, 16, v14
    v_and_b32 v37, 0xffff0000, v14
    v_lshlrev_b32 v38, 16, v15
    v_and_b32 v39, 0xffff0000, v15
    v_pk_add_f32 v[40:41], v[24:25], v[26:27]
    v_pk_add_f32 v[40:41], v[40:41], v[28:29]
    v_pk_add_f32 v[40:41], v[40:41], v[30:31]
    v_pk_add_f32 v[40:41], v[40:41], v[32:33]
    v_pk_add_f32 v[40:41], v[40:41], v[34:35]
    v_pk_add_f32 v[40:41], v[40:41], v[36:37]
    v_pk_add_f32 v[40:41], v[40:41], v[38:39]
    v_add_f32 v40, v40, v41
    s_nop 1
    v_add_f32_dpp v40, v40, v40 row_ror:8 row_mask:0xf bank_mask:0xf
    s_nop 1
    v_add_f32_dpp v40, v40, v40 row_ror:4 row_mask:0xf bank_mask:0xf
    s_nop 1
    v_add_f32_dpp v40, v40, v40 row_ror:2 row_mask:0xf bank_mask:0xf
    s_nop 1
    v_add_f32_dpp v40, v40, v40 row_ror:1 row_mask:0xf bank_mask:0xf
    v_mov_b32 v41, v40
    s_nop 1
    v_permlane16_swap_b32 v40, v41
    s_nop 0
    v_add_f32 v40, v40, v41
    v_mul_f32 v40, 0xbb000000, v40
    v_mov_b32 v41, v40
    v_pk_add_f32 v[42:43], v[24:25], v[40:41]
    v_pk_mul_f32 v[44:45], v[42:43], v[42:43]
    v_pk_add_f32 v[42:43], v[26:27], v[40:41]
    v_pk_fma_f32 v[44:45], v[42:43], v[42:43], v[44:45]
    v_pk_add_f32 v[42:43], v[28:29], v[40:41]
    v_pk_fma_f32 v[44:45], v[42:43], v[42:43], v[44:45]
    v_pk_add_f32 v[42:43], v[30:31], v[40:41]
    v_pk_fma_f32 v[44:45], v[42:43], v[42:43], v[44:45]
    v_pk_add_f32 v[42:43], v[32:33], v[40:41]
    v_pk_fma_f32 v[44:45], v[42:43], v[42:43], v[44:45]
    v_pk_add_f32 v[42:43], v[34:35], v[40:41]
    v_pk_fma_f32 v[44:45], v[42:43], v[42:43], v[44:45]
    v_pk_add_f32 v[42:43], v[36:37], v[40:41]
    v_pk_fma_f32 v[44:45], v[42:43], v[42:43], v[44:45]
    v_pk_add_f32 v[42:43], v[38:39], v[40:41]
    v_pk_fma_f32 v[44:45], v[42:43], v[42:43], v[44:45]
    v_add_f32 v44, v44, v45
    s_nop 1
    v_add_f32_dpp v44, v44, v44 row_ror:8 row_mask:0xf bank_mask:0xf
    s_nop 1
    v_add_f32_dpp v44, v44, v44 row_ror:4 row_mask:0xf bank_mask:0xf
    s_nop 1
    v_add_f32_dpp v44, v44, v44 row_ror:2 row_mask:0xf bank_mask:0xf
    s_nop 1
    v_add_f32_dpp v44, v44, v44 row_ror:1 row_mask:0xf bank_mask:0xf
    v_mov_b32 v45, v44
    s_nop 1
    v_permlane16_swap_b32 v44, v45
    s_nop 0
    v_add_f32 v44, v44, v45
    v_mul_f32 v44, 0x3b000000, v44
    v_cvt_pk_bf16_f32 v44, v44, v44
    v_and_b32 v44, 0xffff0000, v44
    v_add_f32 v44, 0x3727c5ac, v44
    v_cvt_pk_bf16_f32 v44, v44, v44
    v_and_b32 v44, 0xffff0000, v44
    v_sqrt_f32 v44, v44
    s_nop 0
    v_cvt_pk_bf16_f32 v44, v44, v44
    v_and_b32 v44, 0xffff0000, v44
    v_rcp_f32 v44, v44
    v_cvt_pk_bf16_f32 v40, v40, v40
    v_and_b32 v40, 0xffff0000, v40
    v_mov_b32 v41, v40
    v_mov_b32 v45, v44
    v_pk_add_f32 v[42:43], v[24:25], v[40:41]
    v_cvt_pk_bf16_f32 v42, v42, v43
    v_and_b32 v43, 0xffff0000, v42
    v_lshlrev_b32 v42, 16, v42
    v_pk_mul_f32 v[42:43], v[42:43], v[44:45]
    v_cvt_pk_bf16_f32 v8, v42, v43
    v_pk_add_f32 v[42:43], v[26:27], v[40:41]
    v_cvt_pk_bf16_f32 v42, v42, v43
    v_and_b32 v43, 0xffff0000, v42
    v_lshlrev_b32 v42, 16, v42
    v_pk_mul_f32 v[42:43], v[42:43], v[44:45]
    v_cvt_pk_bf16_f32 v9, v42, v43
    v_pk_add_f32 v[42:43], v[28:29], v[40:41]
    v_cvt_pk_bf16_f32 v42, v42, v43
    v_and_b32 v43, 0xffff0000, v42
    v_lshlrev_b32 v42, 16, v42
    v_pk_mul_f32 v[42:43], v[42:43], v[44:45]
    v_cvt_pk_bf16_f32 v10, v42, v43
    v_pk_add_f32 v[42:43], v[30:31], v[40:41]
    v_cvt_pk_bf16_f32 v42, v42, v43
    v_and_b32 v43, 0xffff0000, v42
    v_lshlrev_b32 v42, 16, v42
    v_pk_mul_f32 v[42:43], v[42:43], v[44:45]
    v_cvt_pk_bf16_f32 v11, v42, v43
    v_pk_add_f32 v[42:43], v[32:33], v[40:41]
    v_cvt_pk_bf16_f32 v42, v42, v43
    v_and_b32 v43, 0xffff0000, v42
    v_lshlrev_b32 v42, 16, v42
    v_pk_mul_f32 v[42:43], v[42:43], v[44:45]
    v_cvt_pk_bf16_f32 v12, v42, v43
    v_pk_add_f32 v[42:43], v[34:35], v[40:41]
    v_cvt_pk_bf16_f32 v42, v42, v43
    v_and_b32 v43, 0xffff0000, v42
    v_lshlrev_b32 v42, 16, v42
    v_pk_mul_f32 v[42:43], v[42:43], v[44:45]
    v_cvt_pk_bf16_f32 v13, v42, v43
    v_pk_add_f32 v[42:43], v[36:37], v[40:41]
    v_cvt_pk_bf16_f32 v42, v42, v43
    v_and_b32 v43, 0xffff0000, v42
    v_lshlrev_b32 v42, 16, v42
    v_pk_mul_f32 v[42:43], v[42:43], v[44:45]
    v_cvt_pk_bf16_f32 v14, v42, v43
    v_pk_add_f32 v[42:43], v[38:39], v[40:41]
    v_cvt_pk_bf16_f32 v42, v42, v43
    v_and_b32 v43, 0xffff0000, v42
    v_lshlrev_b32 v42, 16, v42
    v_pk_mul_f32 v[42:43], v[42:43], v[44:45]
    v_cvt_pk_bf16_f32 v15, v42, v43
    v_bfe_u32 v5, v0, 3, 2
    v_lshrrev_b32 v6, 5, v0
    v_mul_u32_u24 v6, 288, v6
    v_and_b32 v7, 7, v0
    v_lshl_add_u32 v6, v7, 5, v6
    v_add_u32 v6, s55, v6
    v_cmp_eq_u32 vcc, s53, v5
    s_and_saveexec_b64 s[56:57], vcc
    ds_write_b128 v6, v[8:11]
    ds_write_b128 v6, v[12:15] offset:16
    s_mov_b64 exec, -1
L_noLN:

    s_cmp_eq_u32 s44, 2
    s_cbranch_scc1 L_notile

L_sl_2:

    ds_read_b128 v[160:163], v1 offset:64

    s_waitcnt lgkmcnt(0)
    v_min3_i32 v160, v160, v161, v162
    v_min_i32 v160, v160, v163
    v_cmp_le_i32 vcc, s45, v160
    s_cbranch_vccz L_sl_2
    ds_read_b64_tr_b16 v[64:65], v16 offset:0
    ds_read_b64_tr_b16 v[66:67], v16 offset:512
    ds_read_b64_tr_b16 v[68:69], v16 offset:4096
    ds_read_b64_tr_b16 v[70:71], v16 offset:4608
    ds_read_b64_tr_b16 v[72:73], v16 offset:8192
    ds_read_b64_tr_b16 v[74:75], v16 offset:8704
    ds_read_b64_tr_b16 v[76:77], v16 offset:12288
    ds_read_b64_tr_b16 v[78:79], v16 offset:12800
    ds_read_b64_tr_b16 v[80:81], v17 offset:0
    ds_read_b64_tr_b16 v[82:83], v17 offset:512
    ds_read_b64_tr_b16 v[84:85], v17 offset:4096
    ds_read_b64_tr_b16 v[86:87], v17 offset:4608
    ds_read_b64_tr_b16 v[88:89], v17 offset:8192
    ds_read_b64_tr_b16 v[90:91], v17 offset:8704
    ds_read_b64_tr_b16 v[92:93], v17 offset:12288
    ds_read_b64_tr_b16 v[94:95], v17 offset:12800
    ds_read_b64_tr_b16 v[96:97], v18 offset:0
    ds_read_b64_tr_b16 v[98:99], v18 offset:512
    ds_read_b64_tr_b16 v[100:101], v18 offset:4096
    ds_read_b64_tr_b16 v[102:103], v18 offset:4608
    ds_read_b64_tr_b16 v[104:105], v18 offset:8192
    ds_read_b64_tr_b16 v[106:107], v18 offset:8704
    ds_read_b64_tr_b16 v[108:109], v18 offset:12288
    ds_read_b64_tr_b16 v[110:111], v18 offset:12800
    ds_read_b64_tr_b16 v[112:113], v19 offset:0
    ds_read_b64_tr_b16 v[114:115], v19 offset:512
    ds_read_b64_tr_b16 v[116:117], v19 offset:4096
    ds_read_b64_tr_b16 v[118:119], v19 offset:4608
    ds_read_b64_tr_b16 v[120:121], v19 offset:8192
    ds_read_b64_tr_b16 v[122:123], v19 offset:8704
    ds_read_b64_tr_b16 v[124:125], v19 offset:12288
    ds_read_b64_tr_b16 v[126:127], v19 offset:12800
    s_waitcnt lgkmcnt(0)
L_notile:

    s_mov_b64 exec, 1
    ds_add_u32 v1, v21 offset:16
    s_mov_b64 exec, -1
    s_cmp_eq_u32 s44, 1
    s_cbranch_scc0 L_noH

    v_bfe_u32 v5, v0, 4, 1
    v_lshlrev_b32 v5, 11, v5
    v_lshrrev_b32 v6, 5, v0
    v_lshl_add_u32 v5, v6, 8, v5
    v_lshl_add_u32 v5, v2, 4, v5
    s_lshl_b32 s56, s53, 12
    s_add_u32 s56, s56, 196608
    v_add_u32 v5, s56, v5
    v_and_b32 v7, 31, v0
    v_lshlrev_b32 v7, 3, v7
    s_lshl_b32 s56, s53, 8
    v_add_u32 v22, s56, v7
    global_load_dwordx2 v[22:23], v22, s[18:19]
    v_mul_u32_u24 v6, 288, v6
    v_add3_u32 v6, v6, v7, s55

    s_mov_b32 s45, 15
L_sl_3:

    ds_read_b128 v[160:163], v1 offset:64

    s_waitcnt lgkmcnt(0)
    v_min3_i32 v160, v160, v161, v162
    v_min_i32 v160, v160, v163
    v_cmp_le_i32 vcc, s45, v160
    s_cbranch_vccz L_sl_3
L_hretry:
    buffer_load_dwordx4 v[24:27], v5, s[36:39], s72 offen offset:0 sc1
    buffer_load_dwordx4 v[28:31], v5, s[36:39], s72 offen offset:512 sc1
    buffer_load_dwordx4 v[32:35], v5, s[36:39], s72 offen offset:1024 sc1
    buffer_load_dwordx4 v[36:39], v5, s[36:39], s72 offen offset:1536 sc1
    s_waitcnt vmcnt(0)
    v_xor_b32 v7, s34, v24
    v_bitop3_b32 v7, v25, s33, v7 bitop3:0xbe
    v_bitop3_b32 v7, v26, s40, v7 bitop3:0xbe
    v_bitop3_b32 v7, v27, s79, v7 bitop3:0xbe
    v_bitop3_b32 v7, v28, s34, v7 bitop3:0xbe
    v_bitop3_b32 v7, v29, s33, v7 bitop3:0xbe
    v_bitop3_b32 v7, v30, s40, v7 bitop3:0xbe
    v_bitop3_b32 v7, v31, s79, v7 bitop3:0xbe
    v_bitop3_b32 v7, v32, s34, v7 bitop3:0xbe
    v_bitop3_b32 v7, v33, s33, v7 bitop3:0xbe
    v_bitop3_b32 v7, v34, s40, v7 bitop3:0xbe
    v_bitop3_b32 v7, v35, s79, v7 bitop3:0xbe
    v_bitop3_b32 v7, v36, s34, v7 bitop3:0xbe
    v_bitop3_b32 v7, v37, s33, v7 bitop3:0xbe
    v_bitop3_b32 v7, v38, s40, v7 bitop3:0xbe
    v_bitop3_b32 v7, v39, s79, v7 bitop3:0xbe
    v_and_b32 v7, v4, v7
    v_cmp_ne_u32 vcc, 0, v7
    s_cbranch_vccz L_hok
L_sp_4:

    ds_read_b32 v7, v1 offset:0

    s_waitcnt lgkmcnt(0)
    v_cmp_le_u32 vcc, 1, v7
    s_cbranch_vccz L_sp_4
    v_readfirstlane_b32 s72, v7
    s_nop 3
    s_and_b32 s72, s72, -2
    s_sub_u32 s43, s43, 1
    s_cbranch_scc0 L_hretry
    s_mov_b32 s43, 0
L_hok:
    v_and_b32 v24, 0xfffff800, v24
    v_and_b32 v25, 0xfffff800, v25
    v_and_b32 v26, 0xfffff800, v26
    v_and_b32 v27, 0xfffff800, v27
    v_and_b32 v28, 0xfffff800, v28
    v_and_b32 v29, 0xfffff800, v29
    v_and_b32 v30, 0xfffff800, v30
    v_and_b32 v31, 0xfffff800, v31
    v_and_b32 v32, 0xfffff800, v32
    v_and_b32 v33, 0xfffff800, v33
    v_and_b32 v34, 0xfffff800, v34
    v_and_b32 v35, 0xfffff800, v35
    v_and_b32 v36, 0xfffff800, v36
    v_and_b32 v37, 0xfffff800, v37
    v_and_b32 v38, 0xfffff800, v38
    v_and_b32 v39, 0xfffff800, v39
    v_pk_add_f32 v[24:25], v[24:25], v[28:29]
    v_pk_add_f32 v[26:27], v[26:27], v[30:31]
    v_pk_add_f32 v[32:33], v[32:33], v[36:37]
    v_pk_add_f32 v[34:35], v[34:35], v[38:39]
    v_pk_add_f32 v[24:25], v[24:25], v[32:33]
    v_pk_add_f32 v[26:27], v[26:27], v[34:35]
    v_cvt_pk_bf16_f32 v24, v24, v25
    v_cvt_pk_bf16_f32 v26, v26, v27
    v_and_b32 v25, 0xffff0000, v24
    v_lshlrev_b32 v24, 16, v24
    v_and_b32 v27, 0xffff0000, v26
    v_lshlrev_b32 v26, 16, v26
    v_lshlrev_b32 v28, 16, v22
    v_and_b32 v29, 0xffff0000, v22
    v_lshlrev_b32 v30, 16, v23
    v_and_b32 v31, 0xffff0000, v23
    v_pk_add_f32 v[24:25], v[24:25], v[28:29]
    v_pk_add_f32 v[26:27], v[26:27], v[30:31]
    v_cvt_pk_bf16_f32 v24, v24, v25
    v_cvt_pk_bf16_f32 v26, v26, v27
    v_and_b32 v25, 0xffff0000, v24
    v_lshlrev_b32 v24, 16, v24
    v_and_b32 v27, 0xffff0000, v26
    v_lshlrev_b32 v26, 16, v26
    v_max_f32 v24, 0, v24
    v_max_f32 v25, 0, v25
    v_max_f32 v26, 0, v26
    v_max_f32 v27, 0, v27
    v_pk_mul_f32 v[24:25], v[24:25], v[24:25]
    v_pk_mul_f32 v[26:27], v[26:27], v[26:27]
    v_cvt_pk_bf16_f32 v24, v24, v25
    v_cvt_pk_bf16_f32 v25, v26, v27
    ds_write_b64 v6, v[24:25]
L_noH:
    s_cmp_eq_u32 s44, 2
    s_cbranch_scc1 L_nopub

    s_waitcnt lgkmcnt(0)
    ds_read_b128 v[24:27], v20 offset:0
    ds_read_b128 v[28:31], v20 offset:64
    ds_read_b128 v[32:35], v20 offset:128
    ds_read_b128 v[36:39], v20 offset:192
    s_cmp_eq_u32 s44, 0
    s_cselect_b32 s56, 8, 4
    s_cselect_b32 s57, 6, 5
    s_cselect_b32 s58, 4, 7
    v_and_b32 v5, 1, v0
    v_lshlrev_b32 v5, s56, v5
    v_bfe_u32 v6, v0, 1, 2
    v_lshl_add_u32 v5, v6, s57, v5
    v_lshl_add_u32 v5, v3, s58, v5
    v_add_u32 v60, s52, v5
    v_and_b32 v6, 2, v0
    v_cmp_ne_u32 s[56:57], 0, v6
    v_and_b32 v6, 4, v0
    v_cmp_ne_u32 s[58:59], 0, v6
    s_waitcnt lgkmcnt(0)

    v_mfma_f32_16x16x32_bf16 v[40:43], v[64:67], v[24:27], 0
    v_mfma_f32_16x16x32_bf16 v[44:47], v[80:83], v[24:27], 0
    v_mfma_f32_16x16x32_bf16 v[48:51], v[96:99], v[24:27], 0
    v_mfma_f32_16x16x32_bf16 v[52:55], v[112:115], v[24:27], 0
    v_mfma_f32_16x16x32_bf16 v[40:43], v[68:71], v[28:31], v[40:43]
    v_mfma_f32_16x16x32_bf16 v[44:47], v[84:87], v[28:31], v[44:47]
    v_mfma_f32_16x16x32_bf16 v[48:51], v[100:103], v[28:31], v[48:51]
    v_mfma_f32_16x16x32_bf16 v[52:55], v[116:119], v[28:31], v[52:55]
    v_mfma_f32_16x16x32_bf16 v[40:43], v[72:75], v[32:35], v[40:43]
    v_mfma_f32_16x16x32_bf16 v[44:47], v[88:91], v[32:35], v[44:47]
    v_mfma_f32_16x16x32_bf16 v[48:51], v[104:107], v[32:35], v[48:51]
    v_mfma_f32_16x16x32_bf16 v[52:55], v[120:123], v[32:35], v[52:55]
    v_mfma_f32_16x16x32_bf16 v[40:43], v[76:79], v[36:39], v[40:43]
    v_mfma_f32_16x16x32_bf16 v[44:47], v[92:95], v[36:39], v[44:47]
    v_mfma_f32_16x16x32_bf16 v[48:51], v[108:111], v[36:39], v[48:51]
    v_mfma_f32_16x16x32_bf16 v[52:55], v[124:127], v[36:39], v[52:55]
    s_nop 7
    v_cndmask_b32 v40, v40, v44, s[56:57]
    v_cndmask_b32 v41, v41, v45, s[56:57]
    v_cndmask_b32 v42, v42, v46, s[56:57]
    v_cndmask_b32 v43, v43, v47, s[56:57]
    v_cndmask_b32 v48, v48, v52, s[56:57]
    v_cndmask_b32 v49, v49, v53, s[56:57]
    v_cndmask_b32 v50, v50, v54, s[56:57]
    v_cndmask_b32 v51, v51, v55, s[56:57]
    v_cndmask_b32 v56, v40, v48, s[58:59]
    v_cndmask_b32 v57, v41, v49, s[58:59]
    v_cndmask_b32 v58, v42, v50, s[58:59]
    v_cndmask_b32 v59, v43, v51, s[58:59]
    v_add_u32 v56, 0x400, v56
    v_add_u32 v57, 0x400, v57
    v_add_u32 v58, 0x400, v58
    v_add_u32 v59, 0x400, v59
    v_bfi_b32 v56, v4, s34, v56
    v_bfi_b32 v57, v4, s33, v57
    v_bfi_b32 v58, v4, s40, v58
    v_bfi_b32 v59, v4, s79, v59
    s_mov_b32 s74, 0x00ff00ff
    s_mov_b32 s75, 0x00ff00ff
    s_mov_b64 exec, s[74:75]
    s_cmp_eq_u32 s44, 0
    s_cbranch_scc0 L_pubB
    buffer_store_dwordx4 v[56:59], v60, s[36:39], 0 offen
    s_branch L_pubE
L_pubB:
    buffer_store_dwordx4 v[56:59], v60, s[36:39], 0 offen sc1
L_pubE:
    s_mov_b64 exec, -1
L_nopub:

    s_cmp_eq_u32 s30, 4
    s_cbranch_scc0 L_final

    v_lshlrev_b32 v10, 9, v3
    v_lshl_add_u32 v10, v2, 4, v10
    s_lshl_b32 s56, s31, 14
    s_lshr_b32 s57, s32, 4
    s_lshl_b32 s57, s57, 8
    s_add_u32 s56, s56, s57
    s_add_u32 s56, s56, 65536
    v_add_u32 v10, s56, v10
    v_add_u32 v11, 0x1000, v10
    v_add_u32 v12, 0x2000, v10
    v_add_u32 v13, 0x3000, v10
    v_lshrrev_b32 v8, 5, v0
    v_lshlrev_b32 v8, 5, v8
    v_lshl_add_u32 v8, v0, 3, v8
    v_add_u32 v8, 147456, v8
    s_sub_u32 s45, s70, 7
    s_getreg_b32 s76, hwreg(HW_REG_XCC_ID, 0, 4)
    s_lshl_b32 s56, s76, 16
    v_mov_b32 v64, s56
    v_mov_b32 v65, 0
    v_mov_b32 v66, 0
    v_mov_b32 v67, 0
    s_lshl_b32 s56, s41, 7
    s_add_u32 s56, s56, 32832
    v_lshl_add_u32 v61, v0, 4, s56
    v_and_b32 v62, 31, v0
    v_lshlrev_b32 v62, 7, v62
    s_lshl_b32 s56, s31, 12
    s_add_u32 s56, s56, 32832
    v_add_u32 v62, s56, v62
    s_mov_b32 s77, 0
    s_mov_b32 s78, 0

    v_bfi_b32 v64, v4, s34, v64
    v_bfi_b32 v65, v4, s33, v65
    v_bfi_b32 v66, v4, s40, v66
    v_bfi_b32 v67, v4, s79, v67
    s_mov_b64 exec, 15
    buffer_store_dwordx4 v[64:67], v61, s[36:39], 0 offen
    s_mov_b64 exec, -1

L_sl_5:

    ds_read_b128 v[160:163], v1 offset:64

    s_waitcnt lgkmcnt(0)
    v_min3_i32 v160, v160, v161, v162
    v_min_i32 v160, v160, v163
    v_cmp_le_i32 vcc, s45, v160
    s_cbranch_vccz L_sl_5
L_qretry:
    buffer_load_dwordx4 v[24:27], v10, s[36:39], s72 offen offset:0 sc1
    buffer_load_dwordx4 v[28:31], v11, s[36:39], s72 offen offset:0 sc1
    buffer_load_dwordx4 v[32:35], v12, s[36:39], s72 offen offset:0 sc1
    buffer_load_dwordx4 v[36:39], v13, s[36:39], s72 offen offset:0 sc1
    buffer_load_dwordx4 v[40:43], v10, s[36:39], s72 offen offset:2048 sc1
    buffer_load_dwordx4 v[44:47], v11, s[36:39], s72 offen offset:2048 sc1
    buffer_load_dwordx4 v[48:51], v12, s[36:39], s72 offen offset:2048 sc1
    buffer_load_dwordx4 v[52:55], v13, s[36:39], s72 offen offset:2048 sc1
    buffer_load_dwordx4 v[68:71], v62, s[36:39], s72 offen sc1
    s_waitcnt vmcnt(0)
    v_xor_b32 v7, s34, v24
    v_bitop3_b32 v7, v25, s33, v7 bitop3:0xbe
    v_bitop3_b32 v7, v26, s40, v7 bitop3:0xbe
    v_bitop3_b32 v7, v27, s79, v7 bitop3:0xbe
    v_bitop3_b32 v7, v28, s34, v7 bitop3:0xbe
    v_bitop3_b32 v7, v29, s33, v7 bitop3:0xbe
    v_bitop3_b32 v7, v30, s40, v7 bitop3:0xbe
    v_bitop3_b32 v7, v31, s79, v7 bitop3:0xbe
    v_bitop3_b32 v7, v32, s34, v7 bitop3:0xbe
    v_bitop3_b32 v7, v33, s33, v7 bitop3:0xbe
    v_bitop3_b32 v7, v34, s40, v7 bitop3:0xbe
    v_bitop3_b32 v7, v35, s79, v7 bitop3:0xbe
    v_bitop3_b32 v7, v36, s34, v7 bitop3:0xbe
    v_bitop3_b32 v7, v37, s33, v7 bitop3:0xbe
    v_bitop3_b32 v7, v38, s40, v7 bitop3:0xbe
    v_bitop3_b32 v7, v39, s79, v7 bitop3:0xbe
    v_bitop3_b32 v7, v40, s34, v7 bitop3:0xbe
    v_bitop3_b32 v7, v41, s33, v7 bitop3:0xbe
    v_bitop3_b32 v7, v42, s40, v7 bitop3:0xbe
    v_bitop3_b32 v7, v43, s79, v7 bitop3:0xbe
    v_bitop3_b32 v7, v44, s34, v7 bitop3:0xbe
    v_bitop3_b32 v7, v45, s33, v7 bitop3:0xbe
    v_bitop3_b32 v7, v46, s40, v7 bitop3:0xbe
    v_bitop3_b32 v7, v47, s79, v7 bitop3:0xbe
    v_bitop3_b32 v7, v48, s34, v7 bitop3:0xbe
    v_bitop3_b32 v7, v49, s33, v7 bitop3:0xbe
    v_bitop3_b32 v7, v50, s40, v7 bitop3:0xbe
    v_bitop3_b32 v7, v51, s79, v7 bitop3:0xbe
    v_bitop3_b32 v7, v52, s34, v7 bitop3:0xbe
    v_bitop3_b32 v7, v53, s33, v7 bitop3:0xbe
    v_bitop3_b32 v7, v54, s40, v7 bitop3:0xbe
    v_bitop3_b32 v7, v55, s79, v7 bitop3:0xbe
    v_bitop3_b32 v7, v68, s34, v7 bitop3:0xbe
    v_bitop3_b32 v7, v69, s33, v7 bitop3:0xbe
    v_bitop3_b32 v7, v70, s40, v7 bitop3:0xbe
    v_bitop3_b32 v7, v71, s79, v7 bitop3:0xbe
    v_and_b32 v7, v4, v7
    v_cmp_ne_u32 vcc, 0, v7
    s_cbranch_vccz L_qok
    s_add_u32 s78, s78, 1
    s_cmp_lt_u32 s78, 3
    s_cbranch_scc1 L_qretry
    s_xor_b32 s72, s72, s73

    s_cmp_eq_u32 s77, 0
    s_cbranch_scc0 L_pb_6
    s_mov_b32 s77, 1
    s_mov_b64 exec, s[74:75]
    buffer_store_dwordx4 v[56:59], v60, s[36:39], s73 offen sc1
    s_mov_b64 exec, 1
    buffer_store_dwordx4 v[64:67], v61, s[36:39], s73 offen sc1
    s_mov_b64 exec, -1
L_pb_6:
    s_sub_u32 s43, s43, 1
    s_cbranch_scc0 L_qretry
    s_mov_b32 s43, 0
L_qok:
    v_lshrrev_b32 v68, 16, v68
    v_cmp_ne_u32 vcc, s76, v68
    s_mov_b32 s72, 0
    s_cbranch_vccz L_qloc
    s_mov_b32 s72, s73

    s_cmp_eq_u32 s77, 0
    s_cbranch_scc0 L_pb_7
    s_mov_b32 s77, 1
    s_mov_b64 exec, s[74:75]
    buffer_store_dwordx4 v[56:59], v60, s[36:39], s73 offen sc1
    s_mov_b64 exec, 1
    buffer_store_dwordx4 v[64:67], v61, s[36:39], s73 offen sc1
    s_mov_b64 exec, -1
L_pb_7:
L_qloc:
    s_add_u32 s56, s72, 1
    v_mov_b32 v9, s56

    v_and_b32 v24, 0xfffff800, v24
    v_and_b32 v25, 0xfffff800, v25
    v_and_b32 v26, 0xfffff800, v26
    v_and_b32 v27, 0xfffff800, v27
    v_and_b32 v28, 0xfffff800, v28
    v_and_b32 v29, 0xfffff800, v29
    v_and_b32 v30, 0xfffff800, v30
    v_and_b32 v31, 0xfffff800, v31
    v_and_b32 v32, 0xfffff800, v32
    v_and_b32 v33, 0xfffff800, v33
    v_and_b32 v34, 0xfffff800, v34
    v_and_b32 v35, 0xfffff800, v35
    v_and_b32 v36, 0xfffff800, v36
    v_and_b32 v37, 0xfffff800, v37
    v_and_b32 v38, 0xfffff800, v38
    v_and_b32 v39, 0xfffff800, v39
    v_and_b32 v40, 0xfffff800, v40
    v_and_b32 v41, 0xfffff800, v41
    v_and_b32 v42, 0xfffff800, v42
    v_and_b32 v43, 0xfffff800, v43
    v_and_b32 v44, 0xfffff800, v44
    v_and_b32 v45, 0xfffff800, v45
    v_and_b32 v46, 0xfffff800, v46
    v_and_b32 v47, 0xfffff800, v47
    v_and_b32 v48, 0xfffff800, v48
    v_and_b32 v49, 0xfffff800, v49
    v_and_b32 v50, 0xfffff800, v50
    v_and_b32 v51, 0xfffff800, v51
    v_and_b32 v52, 0xfffff800, v52
    v_and_b32 v53, 0xfffff800, v53
    v_and_b32 v54, 0xfffff800, v54
    v_and_b32 v55, 0xfffff800, v55
    v_pk_add_f32 v[24:25], v[24:25], v[28:29]
    v_pk_add_f32 v[26:27], v[26:27], v[30:31]
    v_pk_add_f32 v[32:33], v[32:33], v[36:37]
    v_pk_add_f32 v[34:35], v[34:35], v[38:39]
    v_pk_add_f32 v[24:25], v[24:25], v[32:33]
    v_pk_add_f32 v[26:27], v[26:27], v[34:35]
    v_cvt_pk_bf16_f32 v24, v24, v25
    v_cvt_pk_bf16_f32 v25, v26, v27
    ds_write_b64 v8, v[24:25] offset:0

    v_pk_add_f32 v[40:41], v[40:41], v[44:45]
    v_pk_add_f32 v[42:43], v[42:43], v[46:47]
    v_pk_add_f32 v[48:49], v[48:49], v[52:53]
    v_pk_add_f32 v[50:51], v[50:51], v[54:55]
    v_pk_add_f32 v[40:41], v[40:41], v[48:49]
    v_pk_add_f32 v[42:43], v[42:43], v[50:51]
    v_cvt_pk_bf16_f32 v40, v40, v41
    v_cvt_pk_bf16_f32 v41, v42, v43
    ds_write_b64 v8, v[40:41] offset:576

    s_mov_b64 exec, 1
    ds_write_b32 v1, v9 offset:0
    s_mov_b64 exec, -1
    v_and_b32 v5, 31, v0
    v_lshrrev_b32 v6, 5, v0
    v_lshlrev_b32 v9, 4, v5
    v_lshl_add_u32 v9, v6, 2, v9
    v_add_u32 v9, 150784, v9
    v_lshlrev_b32 v5, 7, v5
    v_lshl_add_u32 v5, v6, 4, v5
    s_lshl_b32 s56, s31, 12
    s_add_u32 s56, s56, 32768
    v_add_u32 v5, s56, v5

    s_add_u32 s45, s71, 10
L_sl_8:

    ds_read_b128 v[160:163], v1 offset:64

    s_waitcnt lgkmcnt(0)
    v_min3_i32 v160, v160, v161, v162
    v_min_i32 v160, v160, v163
    v_cmp_le_i32 vcc, s45, v160
    s_cbranch_vccz L_sl_8
L_sp_9:

    ds_read_b32 v7, v1 offset:12

    s_waitcnt lgkmcnt(0)
    v_cmp_le_u32 vcc, 4, v7
    s_cbranch_vccz L_sp_9
L_sretry:
    buffer_load_dwordx4 v[24:27], v5, s[36:39], s72 offen sc1
    buffer_load_dwordx4 v[28:31], v5, s[36:39], s72 offen offset:32 sc1
    s_waitcnt vmcnt(0)
    v_xor_b32 v7, s34, v24
    v_bitop3_b32 v7, v25, s33, v7 bitop3:0xbe
    v_bitop3_b32 v7, v26, s40, v7 bitop3:0xbe
    v_bitop3_b32 v7, v27, s79, v7 bitop3:0xbe
    v_bitop3_b32 v7, v28, s34, v7 bitop3:0xbe
    v_bitop3_b32 v7, v29, s33, v7 bitop3:0xbe
    v_bitop3_b32 v7, v30, s40, v7 bitop3:0xbe
    v_bitop3_b32 v7, v31, s79, v7 bitop3:0xbe
    v_and_b32 v7, v4, v7
    v_cmp_ne_u32 vcc, 0, v7
    s_cbranch_vccz L_ok_10
    s_mov_b64 exec, vcc
    s_sub_u32 s43, s43, 1
    s_cbranch_scc0 L_sretry
    s_mov_b32 s43, 0
L_ok_10:
    s_mov_b64 exec, -1
    v_and_b32 v24, 0xfffff800, v24
    v_and_b32 v28, 0xfffff800, v28
    v_and_b32 v25, 0xfffff800, v25
    v_and_b32 v29, 0xfffff800, v29
    v_max_f32_dpp v26, v24, v24 row_ror:8 row_mask:0xf bank_mask:0xf
    v_max_f32_dpp v30, v28, v28 row_ror:8 row_mask:0xf bank_mask:0xf
    s_nop 0
    v_max_f32_dpp v26, v26, v26 row_ror:4 row_mask:0xf bank_mask:0xf
    v_max_f32_dpp v30, v30, v30 row_ror:4 row_mask:0xf bank_mask:0xf
    s_nop 0
    v_max_f32_dpp v26, v26, v26 row_ror:2 row_mask:0xf bank_mask:0xf
    v_max_f32_dpp v30, v30, v30 row_ror:2 row_mask:0xf bank_mask:0xf
    s_nop 0
    v_max_f32_dpp v26, v26, v26 row_ror:1 row_mask:0xf bank_mask:0xf
    v_max_f32_dpp v30, v30, v30 row_ror:1 row_mask:0xf bank_mask:0xf
    v_sub_f32 v24, v24, v26
    v_sub_f32 v28, v28, v30
    v_mul_f32 v24, 1069066811, v24
    v_mul_f32 v28, 1069066811, v28
    v_exp_f32 v24, v24
    v_exp_f32 v28, v28
    s_nop 0
    v_mul_f32 v25, v24, v25
    v_mul_f32 v29, v28, v29
    s_nop 0
    v_add_f32_dpp v25, v25, v25 row_ror:8 row_mask:0xf bank_mask:0xf
    v_add_f32_dpp v29, v29, v29 row_ror:8 row_mask:0xf bank_mask:0xf
    s_nop 0
    v_add_f32_dpp v25, v25, v25 row_ror:4 row_mask:0xf bank_mask:0xf
    v_add_f32_dpp v29, v29, v29 row_ror:4 row_mask:0xf bank_mask:0xf
    s_nop 0
    v_add_f32_dpp v25, v25, v25 row_ror:2 row_mask:0xf bank_mask:0xf
    v_add_f32_dpp v29, v29, v29 row_ror:2 row_mask:0xf bank_mask:0xf
    s_nop 0
    v_add_f32_dpp v25, v25, v25 row_ror:1 row_mask:0xf bank_mask:0xf
    v_add_f32_dpp v29, v29, v29 row_ror:1 row_mask:0xf bank_mask:0xf
    v_rcp_f32 v25, v25
    v_rcp_f32 v29, v29
    s_nop 0
    v_mul_f32 v24, v24, v25
    v_mul_f32 v28, v28, v29
    ds_write2_b32 v9, v24, v28 offset0:0 offset1:2

    s_mov_b64 exec, 1
    ds_write_b32 v1, v21 offset:24
    s_mov_b64 exec, -1
    s_endpgm
L_final:

    s_cmp_eq_u32 s44, 0
    s_cbranch_scc0 L_fin0

L_sp_11:

    ds_read_b32 v7, v1 offset:0

    s_waitcnt lgkmcnt(0)
    v_cmp_le_u32 vcc, 1, v7
    s_cbranch_vccz L_sp_11
    v_readfirstlane_b32 s72, v7
    s_nop 3
    s_and_b32 s72, s72, -2
    s_cmp_eq_u32 s72, 0
    s_cbranch_scc1 L_fin0
    s_mov_b64 exec, s[74:75]
    buffer_store_dwordx4 v[56:59], v60, s[36:39], s73 offen sc1
    s_mov_b64 exec, -1
L_fin0:
    s_lshr_b32 s63, s32, 3
    s_lshl2_add_u32 s63, s31, s63
    s_mov_b32 s69, s63
    s_lshr_b32 s56, s63, 3
    s_and_b32 s57, s32, 1
    s_bfe_u32 s58, s32, 0x10001
    s_bfe_u32 s59, s32, 0x10002
    s_and_b32 s60, s63, 1
    s_lshl1_add_u32 s59, s60, s59
    s_bfe_u32 s60, s63, 0x20001
    s_lshl2_add_u32 s61, s56, s60
    s_lshl1_add_u32 s62, s61, s58
    s_lshl2_add_u32 s62, s62, s59
    v_and_b32 v5, 1, v3
    v_lshlrev_b32 v5, 1, v5
    v_lshrrev_b32 v6, 1, v3
    v_or_b32 v5, v5, v6
    v_lshlrev_b32 v5, 1, v5
    s_lshl_b32 s63, s62, 3
    v_add_u32 v6, s63, v5
    global_load_ushort v10, v6, s[22:23]
    s_lshl_b32 s63, s57, 10
    v_add_u32 v8, s63, v6
    global_load_ushort v11, v8, s[4:5]
    s_lshr_b32 s63, s62, 4
    s_lshl2_add_u32 s63, s63, s59
    s_lshl_b32 s63, s63, 2
    s_bfe_u32 s61, s62, 0x20002
    s_add_u32 s63, s63, s61
    s_lshl1_add_u32 s63, s63, s57
    s_lshl4_add_u32 s63, s63, 1835008
    v_min_u32 v5, 13, v0
    v_lshlrev_b32 v5, 12, v5
    v_add_u32 v5, s63, v5
    s_and_b32 s61, s32, 7
    s_lshl3_add_u32 s63, s69, s61
    s_lshl4_add_u32 s63, s63, 1572864
    v_lshlrev_b32 v6, 12, v0

    v_add_u32 v6, s63, v6
    s_mov_b32 s59, 0
    v_cmp_gt_u32 s[60:61], 14, v0
    s_mov_b32 s64, s24
    s_mov_b32 s65, s25
    s_mov_b32 s66, 2048
    s_mov_b32 s67, 0x20000
    s_add_u32 s45, s71, 12

L_sl_12:

    ds_read_b128 v[160:163], v1 offset:64

    s_waitcnt lgkmcnt(0)
    v_min3_i32 v160, v160, v161, v162
    v_min_i32 v160, v160, v163
    v_cmp_le_i32 vcc, s45, v160
    s_cbranch_vccz L_sl_12
L_fretry:
    buffer_load_dwordx4 v[24:27], v5, s[36:39], 0 offen sc1
    s_waitcnt vmcnt(0)

    v_xor_b32 v7, s34, v24
    v_bitop3_b32 v7, v25, s33, v7 bitop3:0xbe
    v_bitop3_b32 v7, v26, s40, v7 bitop3:0xbe
    v_bitop3_b32 v7, v27, s79, v7 bitop3:0xbe
    v_and_b32 v7, v4, v7
    v_cmp_ne_u32 vcc, 0, v7
    s_cbranch_vccz L_ok_13
    s_mov_b64 exec, vcc
    s_sub_u32 s43, s43, 1
    s_cbranch_scc0 L_fretry
    s_mov_b32 s43, 0
L_ok_13:
    s_mov_b64 exec, -1
L_sp_14:

    ds_read_b32 v7, v1 offset:4

    s_waitcnt lgkmcnt(0)
    v_cmp_le_u32 vcc, 4, v7
    s_cbranch_vccz L_sp_14
    buffer_load_dwordx4 v[32:35], v6, s[36:39], 0 offen sc1
    v_and_b32 v24, 0xfffff800, v24
    v_and_b32 v25, 0xfffff800, v25
    v_and_b32 v26, 0xfffff800, v26
    v_and_b32 v27, 0xfffff800, v27
    v_cndmask_b32 v24, 0, v24, s[60:61]
    v_cndmask_b32 v25, 0, v25, s[60:61]
    v_cndmask_b32 v26, 0, v26, s[60:61]
    v_cndmask_b32 v27, 0, v27, s[60:61]
    s_nop 1
    v_permlane32_swap_b32 v24, v25
    v_permlane32_swap_b32 v26, v27
    s_nop 0
    v_add_f32 v24, v24, v25
    v_add_f32 v26, v26, v27
    s_nop 1
    v_permlane16_swap_b32 v24, v26
    s_nop 0
    v_add_f32 v24, v24, v26

    s_nop 1
    v_add_f32_dpp v24, v24, v24 row_ror:8 row_mask:0xf bank_mask:0xf
    s_nop 1
    v_add_f32_dpp v24, v24, v24 row_ror:4 row_mask:0xf bank_mask:0xf
    s_nop 1
    v_add_f32_dpp v24, v24, v24 row_ror:2 row_mask:0xf bank_mask:0xf
    s_nop 1
    v_add_f32_dpp v24, v24, v24 row_ror:1 row_mask:0xf bank_mask:0xf
    v_cvt_pk_bf16_f32 v24, v24, v24
    v_and_b32 v24, 0xffff0000, v24
    v_lshlrev_b32 v10, 16, v10
    v_add_f32 v24, v24, v10
    v_cvt_pk_bf16_f32 v24, v24, v24
    v_and_b32 v24, 0xffff0000, v24
    v_mul_f32 v25, 0xbfb8aa3b, v24
    v_exp_f32 v25, v25
    s_nop 0
    v_add_f32 v25, 1.0, v25
    v_rcp_f32 v25, v25
    s_nop 0
    v_mul_f32 v12, v24, v25

    v_cvt_pk_bf16_f32 v12, v12, v12
    v_and_b32 v12, 0xffff0000, v12
    v_lshlrev_b32 v11, 16, v11
    buffer_load_dwordx4 v[36:39], v6, s[36:39], s59 offen sc1
    s_mov_b64 s[62:63], -1
L_3p:
    s_waitcnt vmcnt(1)
    v_xor_b32 v7, s34, v32
    v_bitop3_b32 v7, v33, s33, v7 bitop3:0xbe
    v_bitop3_b32 v7, v34, s40, v7 bitop3:0xbe
    v_bitop3_b32 v7, v35, s79, v7 bitop3:0xbe
    v_and_b32 v7, v4, v7
    v_cmp_ne_u32 vcc, 0, v7
    s_cbranch_vccz L_3X
    s_mov_b64 s[60:61], vcc
    s_mov_b64 exec, vcc
    buffer_load_dwordx4 v[32:35], v6, s[36:39], 0 offen sc1
    s_mov_b64 exec, s[62:63]
    s_waitcnt vmcnt(1)
    v_xor_b32 v7, s34, v36
    v_bitop3_b32 v7, v37, s33, v7 bitop3:0xbe
    v_bitop3_b32 v7, v38, s40, v7 bitop3:0xbe
    v_bitop3_b32 v7, v39, s79, v7 bitop3:0xbe
    v_and_b32 v7, v4, v7
    v_cmp_ne_u32 vcc, 0, v7
    s_cbranch_vccz L_3Y
    s_mov_b64 s[62:63], vcc
    s_mov_b64 exec, vcc
    buffer_load_dwordx4 v[36:39], v6, s[36:39], s59 offen sc1
    s_mov_b64 exec, s[60:61]
    s_sub_u32 s43, s43, 1
    s_cbranch_scc0 L_3p
    s_mov_b32 s43, 0
    s_waitcnt vmcnt(0)
L_3Y:
    s_mov_b64 exec, -1
    v_and_b32 v24, 0xfffff800, v36
    v_and_b32 v25, 0xfffff800, v37
    v_and_b32 v26, 0xfffff800, v38
    v_and_b32 v27, 0xfffff800, v39
    s_branch L_3j
L_3X:
    s_mov_b64 exec, -1
    v_and_b32 v24, 0xfffff800, v32
    v_and_b32 v25, 0xfffff800, v33
    v_and_b32 v26, 0xfffff800, v34
    v_and_b32 v27, 0xfffff800, v35
L_3j:
    s_nop 1
    v_permlane32_swap_b32 v24, v25
    v_permlane32_swap_b32 v26, v27
    s_nop 0
    v_add_f32 v24, v24, v25
    v_add_f32 v26, v26, v27
    s_nop 1
    v_permlane16_swap_b32 v24, v26
    s_nop 0
    v_add_f32 v24, v24, v26

    s_nop 1
    v_add_f32_dpp v24, v24, v24 row_ror:8 row_mask:0xf bank_mask:0xf
    s_nop 1
    v_add_f32_dpp v24, v24, v24 row_ror:4 row_mask:0xf bank_mask:0xf
    s_nop 1
    v_add_f32_dpp v24, v24, v24 row_ror:2 row_mask:0xf bank_mask:0xf
    s_nop 1
    v_add_f32_dpp v24, v24, v24 row_ror:1 row_mask:0xf bank_mask:0xf
    v_cvt_pk_bf16_f32 v24, v24, v24
    v_and_b32 v24, 0xffff0000, v24
    v_mul_f32 v24, v24, v12
    v_cvt_pk_bf16_f32 v24, v24, v24
    v_and_b32 v24, 0xffff0000, v24
    v_add_f32 v24, v24, v11
    v_cvt_pk_bf16_f32 v24, v24, v24
    s_mov_b32 s56, 0x00010001
    s_mov_b32 s57, 0x00010001
    s_mov_b64 exec, s[56:57]
    buffer_store_short v24, v8, s[64:67], 0 offen
    s_cmp_eq_u32 s2, 0
    s_cbranch_scc0 L_fin2
    s_mov_b64 exec, 1
    v_mov_b32 v26, s34
    v_mov_b32 v27, s35
    v_mov_b32 v28, 0
    buffer_store_dwordx2 v[26:27], v28, s[36:39], 0 offen
L_fin2:

    s_endpgm
L_compute:
    s_setprio 1
    s_sub_u32 s44, s30, 6

    v_mov_b32 v64, 0
    v_mov_b32 v65, 0
    v_mov_b32 v66, 0
    v_mov_b32 v67, 0
    v_mov_b32 v68, 0
    v_mov_b32 v69, 0
    v_mov_b32 v70, 0
    v_mov_b32 v71, 0
    v_mov_b32 v72, 0
    v_mov_b32 v73, 0
    v_mov_b32 v74, 0
    v_mov_b32 v75, 0
    v_mov_b32 v76, 0
    v_mov_b32 v77, 0
    v_mov_b32 v78, 0
    v_mov_b32 v79, 0
    v_mov_b32 v80, 0
    v_mov_b32 v81, 0
    v_mov_b32 v82, 0
    v_mov_b32 v83, 0
    v_mov_b32 v84, 0
    v_mov_b32 v85, 0
    v_mov_b32 v86, 0
    v_mov_b32 v87, 0
    v_mov_b32 v88, 0
    v_mov_b32 v89, 0
    v_mov_b32 v90, 0
    v_mov_b32 v91, 0
    v_mov_b32 v92, 0
    v_mov_b32 v93, 0
    v_mov_b32 v94, 0
    v_mov_b32 v95, 0
    v_mov_b32 v96, 0
    v_mov_b32 v97, 0
    v_mov_b32 v98, 0
    v_mov_b32 v99, 0
    v_mov_b32 v100, 0
    v_mov_b32 v101, 0
    v_mov_b32 v102, 0
    v_mov_b32 v103, 0
    v_mov_b32 v104, 0
    v_mov_b32 v105, 0
    v_mov_b32 v106, 0
    v_mov_b32 v107, 0
    v_mov_b32 v108, 0
    v_mov_b32 v109, 0
    v_mov_b32 v110, 0
    v_mov_b32 v111, 0
    v_mov_b32 v112, 0
    v_mov_b32 v113, 0
    v_mov_b32 v114, 0
    v_mov_b32 v115, 0
    v_mov_b32 v116, 0
    v_mov_b32 v117, 0
    v_mov_b32 v118, 0
    v_mov_b32 v119, 0
    v_mov_b32 v120, 0
    v_mov_b32 v121, 0
    v_mov_b32 v122, 0
    v_mov_b32 v123, 0
    v_mov_b32 v124, 0
    v_mov_b32 v125, 0
    v_mov_b32 v126, 0
    v_mov_b32 v127, 0
    s_lshl_b32 s45, s44, 14
    v_lshlrev_b32 v5, 8, v2
    v_add_u32 v5, s45, v5
    v_xor_b32 v6, v3, v2

    v_xor_b32 v7, 0, v6
    v_lshl_add_u32 v8, v7, 4, v5
    v_xor_b32 v7, 4, v6
    v_lshl_add_u32 v9, v7, 4, v5
    v_xor_b32 v7, 8, v6
    v_lshl_add_u32 v10, v7, 4, v5
    v_xor_b32 v7, 12, v6
    v_lshl_add_u32 v11, v7, 4, v5
    v_and_b32 v13, 3, v2
    v_mul_u32_u24 v12, 288, v13
    v_lshl_add_u32 v12, v3, 4, v12
    v_add_u32 v12, 147456, v12

    v_lshl_add_u32 v15, v3, 2, v13
    v_lshlrev_b32 v15, 4, v15
    v_add_u32 v15, 148608, v15
    v_lshrrev_b32 v5, 3, v2
    v_lshl_add_u32 v14, v5, 8, v15
    v_bfe_u32 v5, v2, 2, 1
    v_lshl_add_u32 v14, v5, 3, v14
    s_lshl_b32 s45, s44, 9
    v_add_u32 v14, s45, v14
    v_lshlrev_b32 v17, 3, v13
    v_add_u32 v17, 150656, v17
    s_lshl_b32 s45, s44, 5
    v_add_u32 v16, s45, v17

    v_lshrrev_b32 v5, 2, v2
    v_and_b32 v6, 1, v3
    v_lshl_add_u32 v6, v6, 2, v5
    s_lshl_b32 s45, s44, 1
    v_xor_b32 v6, s45, v6
    v_lshlrev_b32 v7, 3, v13
    v_lshl_add_u32 v22, v6, 5, v7
    v_xor_b32 v23, 32, v22
    v_lshl_add_u32 v6, v3, 2, v5
    v_lshlrev_b32 v6, 8, v6
    v_add_u32 v6, 65536, v6
    v_add_u32 v18, v6, v22
    v_add_u32 v19, v6, v23
    v_lshl_add_u32 v6, v3, 3, v5
    v_lshlrev_b32 v6, 8, v6
    v_add_u32 v6, 131072, v6
    v_add_u32 v20, v6, v22
    v_add_u32 v21, v6, v23

    s_lshl_b32 s45, s44, 7
    v_lshl_add_u32 v5, v3, 4, s45
    s_lshl_b32 s46, s41, 11
    s_add_u32 s46, s46, 262144
    s_lshl2_add_u32 s46, s45, s46
    v_lshl_add_u32 v22, v0, 4, s46
    s_lshl_b32 s46, s41, 10

    s_add_u32 s46, s46, 1572864
    s_lshl1_add_u32 s46, s45, s46
    v_lshlrev_b32 v23, 4, v13
    v_lshl_add_u32 v23, v3, 6, v23
    v_add_u32 v23, s46, v23
    v_and_b32 v6, 1, v2
    v_lshlrev_b32 v28, 7, v6
    v_lshl_add_u32 v28, v3, 4, v28
    v_add_u32 v28, 151296, v28
    s_lshr_b32 s45, s44, 1
    s_and_b32 s46, s44, 1
    s_lshl_b32 s47, s31, 16
    s_lshl_b32 s48, s45, 15
    s_add_u32 s47, s47, s48
    s_lshr_b32 s48, s32, 2
    s_lshl_b32 s48, s48, 8
    s_add_u32 s47, s47, s48
    s_lshl_b32 s48, s46, 7
    s_add_u32 s47, s47, s48
    s_add_u32 s47, s47, 262144
    v_lshrrev_b32 v5, 3, v0
    v_and_b32 v6, 7, v0
    v_lshlrev_b32 v24, 11, v5
    v_lshl_add_u32 v24, v6, 4, v24
    v_add_u32 v24, s47, v24
    v_add_u32 v25, 16384, v24
    s_lshl_b32 s47, s45, 8
    s_add_u32 s47, s47, 150784
    v_lshl_add_u32 v26, v5, 4, s47
    v_and_b32 v5, 1, v3
    v_lshlrev_b32 v5, 1, v5
    v_lshrrev_b32 v7, 1, v3
    v_or_b32 v5, v5, v7
    v_lshl_add_u32 v5, v5, 4, v6
    s_lshl_b32 s47, s45, 7
    s_lshl_b32 s48, s46, 4
    s_add_u32 s47, s47, s48
    s_add_u32 s47, s47, 151296
    v_lshl_add_u32 v27, v5, 1, s47
    s_lshl_b32 s47, s41, 7
    s_add_u32 s47, s47, 32768
    v_lshl_add_u32 v29, v13, 4, s47
    v_and_b32 v5, 4, v0
    v_cmp_ne_u32 s[50:51], 0, v5
    v_and_b32 v5, 2, v0
    v_cmp_ne_u32 s[52:53], 0, v5
    v_mov_b32 v30, 1
    s_waitcnt lgkmcnt(0)

    s_add_u32 s34, s34, 0x01401801
    s_addc_u32 s35, s35, 14
    s_lshr_b32 s33, s34, 11
    s_lshr_b64 s[46:47], s[34:35], 22
    s_mov_b32 s40, s46
    s_lshr_b32 s79, s35, 1

    s_add_u32 s56, s42, 0
    s_and_b32 s56, s56, 3
    s_lshl_b32 s57, s56, 9
    v_add_u32 v40, s57, v15
    s_lshl_b32 s57, s56, 14
    v_add_u32 v48, s57, v18
    v_add_u32 v49, s57, v19

    s_add_u32 s56, s42, 1
    s_and_b32 s56, s56, 3
    s_lshl_b32 s57, s56, 9
    v_add_u32 v41, s57, v15
    s_lshl_b32 s57, s56, 14
    v_add_u32 v50, s57, v18
    v_add_u32 v51, s57, v19

    s_add_u32 s56, s42, 2
    s_and_b32 s56, s56, 3
    s_lshl_b32 s57, s56, 9
    v_add_u32 v42, s57, v15
    s_lshl_b32 s57, s56, 14
    v_add_u32 v52, s57, v18
    v_add_u32 v53, s57, v19

    s_add_u32 s56, s42, 3
    s_and_b32 s56, s56, 3
    s_lshl_b32 s57, s56, 9
    v_add_u32 v43, s57, v15
    s_lshl_b32 s57, s56, 14
    v_add_u32 v54, s57, v18
    v_add_u32 v55, s57, v19

L_sp_15:

    ds_read_b32 v6, v1 offset:0

    s_waitcnt lgkmcnt(0)
    v_cmp_le_u32 vcc, 1, v6
    s_cbranch_vccz L_sp_15
    v_readfirstlane_b32 s72, v6
    s_nop 3
    s_and_b32 s72, s72, -2
    s_mov_b32 s54, 0xf000f
    s_mov_b32 s55, 0xf000f
    s_mov_b64 exec, s[54:55]
    ds_read_b128 v[64:67], v12 offset:0
    ds_read_b128 v[68:71], v12 offset:64
    ds_read_b128 v[72:75], v12 offset:128
    ds_read_b128 v[76:79], v12 offset:192
    s_mov_b32 s54, 0xf000f0
    s_mov_b32 s55, 0xf000f0
    s_mov_b64 exec, s[54:55]
    ds_read_b128 v[80:83], v12 offset:0
    ds_read_b128 v[84:87], v12 offset:64
    ds_read_b128 v[88:91], v12 offset:128
    ds_read_b128 v[92:95], v12 offset:192
    s_mov_b32 s54, 0xf000f00
    s_mov_b32 s55, 0xf000f00
    s_mov_b64 exec, s[54:55]
    ds_read_b128 v[96:99], v12 offset:0
    ds_read_b128 v[100:103], v12 offset:64
    ds_read_b128 v[104:107], v12 offset:128
    ds_read_b128 v[108:111], v12 offset:192
    s_mov_b32 s54, 0xf000f000
    s_mov_b32 s55, 0xf000f000
    s_mov_b64 exec, s[54:55]
    ds_read_b128 v[112:115], v12 offset:0
    ds_read_b128 v[116:119], v12 offset:64
    ds_read_b128 v[120:123], v12 offset:128
    ds_read_b128 v[124:127], v12 offset:192
    s_mov_b64 exec, -1
    s_sub_u32 s58, s44, s42
    s_and_b32 s58, s58, 3
    s_lshl2_add_u32 s58, s58, s70
    s_sub_u32 s58, s58, 12

L_sl_16:

    ds_read_b128 v[160:163], v1 offset:64

    s_waitcnt lgkmcnt(0)
    v_min3_i32 v160, v160, v161, v162
    v_min_i32 v160, v160, v163
    v_cmp_le_i32 vcc, s58, v160
    s_cbranch_vccz L_sl_16
    ds_read_b128 v[128:131], v8 offset:0
    ds_read_b128 v[132:135], v9 offset:0
    ds_read_b128 v[136:139], v10 offset:0
    ds_read_b128 v[140:143], v11 offset:0
    ds_read_b128 v[144:147], v8 offset:4096
    ds_read_b128 v[148:151], v9 offset:4096
    ds_read_b128 v[152:155], v10 offset:4096
    ds_read_b128 v[156:159], v11 offset:4096
    s_waitcnt lgkmcnt(7)
    v_mfma_f32_16x16x32_bf16 v[32:35], v[128:131], v[64:67], 0
    ds_read_b128 v[128:131], v8 offset:8192
    s_waitcnt lgkmcnt(7)
    v_mfma_f32_16x16x32_bf16 v[32:35], v[132:135], v[68:71], v[32:35]
    ds_read_b128 v[132:135], v9 offset:8192
    s_waitcnt lgkmcnt(7)
    v_mfma_f32_16x16x32_bf16 v[32:35], v[136:139], v[72:75], v[32:35]
    ds_read_b128 v[136:139], v10 offset:8192
    s_waitcnt lgkmcnt(7)
    v_mfma_f32_16x16x32_bf16 v[32:35], v[140:143], v[76:79], v[32:35]
    ds_read_b128 v[140:143], v11 offset:8192
    s_waitcnt lgkmcnt(7)
    v_mfma_f32_16x16x32_bf16 v[32:35], v[144:147], v[80:83], v[32:35]
    ds_read_b128 v[144:147], v8 offset:12288
    s_waitcnt lgkmcnt(7)
    v_mfma_f32_16x16x32_bf16 v[32:35], v[148:151], v[84:87], v[32:35]
    ds_read_b128 v[148:151], v9 offset:12288
    s_waitcnt lgkmcnt(7)
    v_mfma_f32_16x16x32_bf16 v[32:35], v[152:155], v[88:91], v[32:35]
    ds_read_b128 v[152:155], v10 offset:12288
    s_waitcnt lgkmcnt(7)
    v_mfma_f32_16x16x32_bf16 v[32:35], v[156:159], v[92:95], v[32:35]
    ds_read_b128 v[156:159], v11 offset:12288
    s_waitcnt lgkmcnt(7)
    v_mfma_f32_16x16x32_bf16 v[32:35], v[128:131], v[96:99], v[32:35]
    s_waitcnt lgkmcnt(6)
    v_mfma_f32_16x16x32_bf16 v[32:35], v[132:135], v[100:103], v[32:35]
    s_waitcnt lgkmcnt(5)
    v_mfma_f32_16x16x32_bf16 v[32:35], v[136:139], v[104:107], v[32:35]
    s_waitcnt lgkmcnt(4)
    v_mfma_f32_16x16x32_bf16 v[32:35], v[140:143], v[108:111], v[32:35]
    s_waitcnt lgkmcnt(3)
    v_mfma_f32_16x16x32_bf16 v[32:35], v[144:147], v[112:115], v[32:35]
    s_waitcnt lgkmcnt(2)
    v_mfma_f32_16x16x32_bf16 v[32:35], v[148:151], v[116:119], v[32:35]
    s_waitcnt lgkmcnt(1)
    v_mfma_f32_16x16x32_bf16 v[32:35], v[152:155], v[120:123], v[32:35]
    s_waitcnt lgkmcnt(0)
    v_mfma_f32_16x16x32_bf16 v[32:35], v[156:159], v[124:127], v[32:35]
    s_mov_b32 s54, 0x3db504f3
    s_mov_b32 s55, 0x3fb8aa3b
    s_nop 5
    v_cvt_pk_bf16_f32 v32, v32, v33
    v_cvt_pk_bf16_f32 v34, v34, v35
    v_and_b32 v33, 0xffff0000, v32
    v_lshlrev_b32 v32, 16, v32
    v_and_b32 v35, 0xffff0000, v34
    v_lshlrev_b32 v34, 16, v34
    v_mul_f32 v32, s54, v32
    v_mul_f32 v33, s54, v33
    v_mul_f32 v34, s54, v34
    v_mul_f32 v35, s54, v35
    v_cvt_pk_bf16_f32 v32, v32, v33
    v_cvt_pk_bf16_f32 v34, v34, v35
    v_and_b32 v33, 0xffff0000, v32
    v_lshlrev_b32 v32, 16, v32
    v_and_b32 v35, 0xffff0000, v34
    v_lshlrev_b32 v34, 16, v34
    v_max_f32 v36, v32, v33
    v_max3_f32 v36, v34, v35, v36

    s_nop 1
    v_max_f32_dpp v36, v36, v36 row_ror:8 row_mask:0xf bank_mask:0xf
    s_nop 1
    v_max_f32_dpp v36, v36, v36 row_ror:4 row_mask:0xf bank_mask:0xf
    v_mov_b32 v37, v36
    s_nop 1
    v_permlane16_swap_b32 v36, v37
    s_nop 0
    v_max_f32 v36, v36, v37
    v_mov_b32 v37, v36
    s_nop 1
    v_permlane32_swap_b32 v36, v37
    s_nop 0
    v_max_f32 v36, v36, v37
    v_sub_f32 v32, v32, v36
    v_sub_f32 v33, v33, v36
    v_sub_f32 v34, v34, v36
    v_sub_f32 v35, v35, v36
    v_mul_f32 v32, s55, v32
    v_mul_f32 v33, s55, v33
    v_mul_f32 v34, s55, v34
    v_mul_f32 v35, s55, v35
    v_exp_f32 v128, v32
    v_exp_f32 v129, v33
    v_exp_f32 v130, v34
    v_exp_f32 v131, v35
    v_add_f32 v37, v128, v129
    s_nop 0
    v_add_f32 v38, v130, v131
    v_add_f32 v37, v37, v38

    s_nop 1
    v_add_f32_dpp v37, v37, v37 row_ror:8 row_mask:0xf bank_mask:0xf
    s_nop 1
    v_add_f32_dpp v37, v37, v37 row_ror:4 row_mask:0xf bank_mask:0xf
    v_mov_b32 v38, v37
    s_nop 1
    v_permlane16_swap_b32 v37, v38
    s_nop 0
    v_add_f32 v37, v37, v38
    v_mov_b32 v38, v37
    s_nop 1
    v_permlane32_swap_b32 v37, v38
    s_nop 0
    v_add_f32 v37, v37, v38
    s_mov_b64 exec, 15
    ds_write_b64 v16, v[36:37]
    s_mov_b64 exec, 1
    ds_add_u32 v1, v30 offset:12
    s_mov_b64 exec, -1

L_sp_17:

    ds_read_b32 v6, v1 offset:12
    ds_read_b64 v[56:57], v17 offset:0
    ds_read_b64 v[58:59], v17 offset:32
    ds_read_b64 v[60:61], v17 offset:64
    ds_read_b64 v[62:63], v17 offset:96
    s_waitcnt lgkmcnt(0)
    v_cmp_le_u32 vcc, 4, v6
    s_cbranch_vccz L_sp_17
    v_max_f32 v32, v56, v58
    v_max3_f32 v32, v60, v62, v32
    v_sub_f32 v56, v56, v32
    v_sub_f32 v58, v58, v32
    v_sub_f32 v60, v60, v32
    v_sub_f32 v62, v62, v32
    v_sub_f32 v36, v36, v32
    v_mul_f32 v56, s55, v56
    v_mul_f32 v58, s55, v58
    v_mul_f32 v60, s55, v60
    v_mul_f32 v62, s55, v62
    v_mul_f32 v36, s55, v36
    v_exp_f32 v56, v56
    v_exp_f32 v58, v58
    v_exp_f32 v60, v60
    v_exp_f32 v62, v62
    v_exp_f32 v36, v36
    v_mul_f32 v33, v56, v57
    v_fmac_f32 v33, v58, v59
    v_fmac_f32 v33, v60, v61
    v_fmac_f32 v33, v62, v63
    v_mov_b32 v34, 0
    v_mov_b32 v35, 0

    s_cmp_eq_u32 s44, 0
    s_cbranch_scc0 L_nostat
    v_bfi_b32 v32, v4, s34, v32
    v_bfi_b32 v33, v4, s33, v33
    v_bfi_b32 v34, v4, s40, v34
    v_bfi_b32 v35, v4, s79, v35
    s_mov_b64 exec, 15
    buffer_store_dwordx4 v[32:35], v29, s[36:39], 0 offen
    s_cmp_eq_u32 s72, 0
    s_cbranch_scc1 L_nostatB
    buffer_store_dwordx4 v[32:35], v29, s[36:39], s73 offen sc1
L_nostatB:
    s_mov_b64 exec, -1
L_nostat:

    v_mul_f32 v128, v128, v36
    v_mul_f32 v129, v129, v36
    v_mul_f32 v130, v130, v36
    v_mul_f32 v131, v131, v36
    v_cvt_pk_bf16_f32 v128, v128, v129
    v_cvt_pk_bf16_f32 v129, v130, v131
    ds_write_b64 v14, v[128:129]

    s_mov_b64 exec, 1
    ds_add_u32 v1, v30 offset:8
    s_mov_b64 exec, -1
    v_mov_b32 v96, 0
    v_mov_b32 v97, 0
    v_mov_b32 v98, 0
    v_mov_b32 v99, 0
    v_mov_b32 v100, 0
    v_mov_b32 v101, 0
    v_mov_b32 v102, 0
    v_mov_b32 v103, 0
    v_mov_b32 v104, 0
    v_mov_b32 v105, 0
    v_mov_b32 v106, 0
    v_mov_b32 v107, 0
    v_mov_b32 v108, 0
    v_mov_b32 v109, 0
    v_mov_b32 v110, 0
    v_mov_b32 v111, 0
    v_mov_b32 v112, 0
    v_mov_b32 v113, 0
    v_mov_b32 v114, 0
    v_mov_b32 v115, 0
    v_mov_b32 v116, 0
    v_mov_b32 v117, 0
    v_mov_b32 v118, 0
    v_mov_b32 v119, 0
    v_mov_b32 v120, 0
    v_mov_b32 v121, 0
    v_mov_b32 v122, 0
    v_mov_b32 v123, 0
    v_mov_b32 v124, 0
    v_mov_b32 v125, 0
    v_mov_b32 v126, 0
    v_mov_b32 v127, 0
L_sp_18:

    ds_read_b32 v6, v1 offset:8

    s_waitcnt lgkmcnt(0)
    v_cmp_le_u32 vcc, 4, v6
    s_cbranch_vccz L_sp_18
    s_mov_b32 s56, 0xf000f
    s_mov_b32 s57, 0xf000f
    s_mov_b64 exec, s[56:57]
    ds_read_b128 v[64:67], v40 offset:0
    ds_read_b128 v[68:71], v40 offset:256
    ds_read_b128 v[72:75], v41 offset:0
    ds_read_b128 v[76:79], v41 offset:256
    ds_read_b128 v[96:99], v42 offset:0
    ds_read_b128 v[100:103], v42 offset:256
    ds_read_b128 v[104:107], v43 offset:0
    ds_read_b128 v[108:111], v43 offset:256
    s_mov_b32 s56, 0xf000f0
    s_mov_b32 s57, 0xf000f0
    s_mov_b64 exec, s[56:57]
    ds_read_b128 v[80:83], v40 offset:0
    ds_read_b128 v[84:87], v40 offset:256
    ds_read_b128 v[88:91], v41 offset:0
    ds_read_b128 v[92:95], v41 offset:256
    ds_read_b128 v[112:115], v42 offset:0
    ds_read_b128 v[116:119], v42 offset:256
    ds_read_b128 v[120:123], v43 offset:0
    ds_read_b128 v[124:127], v43 offset:256
    s_mov_b64 exec, -1
    s_add_u32 s58, s71, 4
L_sl_19:

    ds_read_b128 v[160:163], v1 offset:64

    s_waitcnt lgkmcnt(0)
    v_min3_i32 v160, v160, v161, v162
    v_min_i32 v160, v160, v163
    v_cmp_le_i32 vcc, s58, v160
    s_cbranch_vccz L_sl_19
    ds_read_b64_tr_b16 v[128:129], v48 offset:0
    ds_read_b64_tr_b16 v[130:131], v48 offset:4096
    ds_read_b64_tr_b16 v[132:133], v49 offset:0
    ds_read_b64_tr_b16 v[134:135], v49 offset:4096
    ds_read_b64_tr_b16 v[136:137], v48 offset:8192
    ds_read_b64_tr_b16 v[138:139], v48 offset:12288
    ds_read_b64_tr_b16 v[140:141], v49 offset:8192
    ds_read_b64_tr_b16 v[142:143], v49 offset:12288
    s_waitcnt lgkmcnt(6)
    v_mfma_f32_16x16x32_bf16 v[144:147], v[64:67], v[128:131], 0
    s_waitcnt lgkmcnt(4)
    v_mfma_f32_16x16x32_bf16 v[144:147], v[80:83], v[132:135], v[144:147]
    s_waitcnt lgkmcnt(2)
    v_mfma_f32_16x16x32_bf16 v[144:147], v[68:71], v[136:139], v[144:147]
    s_waitcnt lgkmcnt(0)
    v_mfma_f32_16x16x32_bf16 v[144:147], v[84:87], v[140:143], v[144:147]
    s_add_u32 s58, s71, 8
L_sl_20:

    ds_read_b128 v[160:163], v1 offset:64

    s_waitcnt lgkmcnt(0)
    v_min3_i32 v160, v160, v161, v162
    v_min_i32 v160, v160, v163
    v_cmp_le_i32 vcc, s58, v160
    s_cbranch_vccz L_sl_20
    ds_read_b64_tr_b16 v[128:129], v50 offset:0
    ds_read_b64_tr_b16 v[130:131], v50 offset:4096
    ds_read_b64_tr_b16 v[132:133], v51 offset:0
    ds_read_b64_tr_b16 v[134:135], v51 offset:4096
    ds_read_b64_tr_b16 v[136:137], v50 offset:8192
    ds_read_b64_tr_b16 v[138:139], v50 offset:12288
    ds_read_b64_tr_b16 v[140:141], v51 offset:8192
    ds_read_b64_tr_b16 v[142:143], v51 offset:12288
    s_waitcnt lgkmcnt(6)
    v_mfma_f32_16x16x32_bf16 v[144:147], v[72:75], v[128:131], v[144:147]
    s_waitcnt lgkmcnt(4)
    v_mfma_f32_16x16x32_bf16 v[144:147], v[88:91], v[132:135], v[144:147]
    s_waitcnt lgkmcnt(2)
    v_mfma_f32_16x16x32_bf16 v[144:147], v[76:79], v[136:139], v[144:147]
    s_waitcnt lgkmcnt(0)
    v_mfma_f32_16x16x32_bf16 v[144:147], v[92:95], v[140:143], v[144:147]
    s_add_u32 s58, s71, 12
L_sl_21:

    ds_read_b128 v[160:163], v1 offset:64

    s_waitcnt lgkmcnt(0)
    v_min3_i32 v160, v160, v161, v162
    v_min_i32 v160, v160, v163
    v_cmp_le_i32 vcc, s58, v160
    s_cbranch_vccz L_sl_21
    ds_read_b64_tr_b16 v[128:129], v52 offset:0
    ds_read_b64_tr_b16 v[130:131], v52 offset:4096
    ds_read_b64_tr_b16 v[132:133], v53 offset:0
    ds_read_b64_tr_b16 v[134:135], v53 offset:4096
    ds_read_b64_tr_b16 v[136:137], v52 offset:8192
    ds_read_b64_tr_b16 v[138:139], v52 offset:12288
    ds_read_b64_tr_b16 v[140:141], v53 offset:8192
    ds_read_b64_tr_b16 v[142:143], v53 offset:12288
    s_waitcnt lgkmcnt(6)
    v_mfma_f32_16x16x32_bf16 v[144:147], v[96:99], v[128:131], v[144:147]
    s_waitcnt lgkmcnt(4)
    v_mfma_f32_16x16x32_bf16 v[144:147], v[112:115], v[132:135], v[144:147]
    s_waitcnt lgkmcnt(2)
    v_mfma_f32_16x16x32_bf16 v[144:147], v[100:103], v[136:139], v[144:147]
    s_waitcnt lgkmcnt(0)
    v_mfma_f32_16x16x32_bf16 v[144:147], v[116:119], v[140:143], v[144:147]
    s_add_u32 s58, s71, 16
L_sl_22:

    ds_read_b128 v[160:163], v1 offset:64

    s_waitcnt lgkmcnt(0)
    v_min3_i32 v160, v160, v161, v162
    v_min_i32 v160, v160, v163
    v_cmp_le_i32 vcc, s58, v160
    s_cbranch_vccz L_sl_22
    ds_read_b64_tr_b16 v[128:129], v54 offset:0
    ds_read_b64_tr_b16 v[130:131], v54 offset:4096
    ds_read_b64_tr_b16 v[132:133], v55 offset:0
    ds_read_b64_tr_b16 v[134:135], v55 offset:4096
    ds_read_b64_tr_b16 v[136:137], v54 offset:8192
    ds_read_b64_tr_b16 v[138:139], v54 offset:12288
    ds_read_b64_tr_b16 v[140:141], v55 offset:8192
    ds_read_b64_tr_b16 v[142:143], v55 offset:12288
    s_waitcnt lgkmcnt(6)
    v_mfma_f32_16x16x32_bf16 v[144:147], v[104:107], v[128:131], v[144:147]
    s_waitcnt lgkmcnt(4)
    v_mfma_f32_16x16x32_bf16 v[144:147], v[120:123], v[132:135], v[144:147]
    s_waitcnt lgkmcnt(2)
    v_mfma_f32_16x16x32_bf16 v[144:147], v[108:111], v[136:139], v[144:147]
    s_waitcnt lgkmcnt(0)
    v_mfma_f32_16x16x32_bf16 v[144:147], v[124:127], v[140:143], v[144:147]
    s_cmp_eq_u32 s72, 0
    s_mov_b32 exec_hi, 0
    s_nop 5
    v_bfi_b32 v144, v4, s34, v144
    v_bfi_b32 v145, v4, s33, v145
    v_bfi_b32 v146, v4, s40, v146
    v_bfi_b32 v147, v4, s79, v147
    buffer_store_dwordx4 v[144:147], v22, s[36:39], 0 offen
    s_cbranch_scc1 L_oloc
    buffer_store_dwordx4 v[144:147], v22, s[36:39], s73 offen sc1
L_oloc:
    s_mov_b64 exec, -1

    buffer_load_dwordx4 v[32:35], v24, s[36:39], s72 offen sc1
    buffer_load_dwordx4 v[36:39], v25, s[36:39], s72 offen sc1
    s_add_u32 s58, s71, 20

L_sp_23:

    ds_read_b32 v6, v1 offset:24
    ds_read_b128 v[40:43], v26
    ds_read_b128 v[44:47], v26 offset:128
    s_waitcnt lgkmcnt(0)
    v_cmp_le_u32 vcc, 1, v6
    s_cbranch_vccz L_sp_23
    buffer_load_dwordx4 v[48:51], v24, s[36:39], s72 offen sc1
    buffer_load_dwordx4 v[52:55], v25, s[36:39], s72 offen sc1
    s_mov_b64 s[62:63], -1
L_op:
    s_waitcnt vmcnt(2)
    v_xor_b32 v7, s34, v32
    v_bitop3_b32 v7, v33, s33, v7 bitop3:0xbe
    v_bitop3_b32 v7, v34, s40, v7 bitop3:0xbe
    v_bitop3_b32 v7, v35, s79, v7 bitop3:0xbe
    v_bitop3_b32 v7, v36, s34, v7 bitop3:0xbe
    v_bitop3_b32 v7, v37, s33, v7 bitop3:0xbe
    v_bitop3_b32 v7, v38, s40, v7 bitop3:0xbe
    v_bitop3_b32 v7, v39, s79, v7 bitop3:0xbe
    v_and_b32 v7, v4, v7
    v_cmp_ne_u32 vcc, 0, v7
    s_cbranch_vccz L_okX
    s_mov_b64 s[60:61], vcc
    s_mov_b64 exec, vcc
    buffer_load_dwordx4 v[32:35], v24, s[36:39], s72 offen sc1
    buffer_load_dwordx4 v[36:39], v25, s[36:39], s72 offen sc1
    s_mov_b64 exec, s[62:63]
    s_waitcnt vmcnt(2)
    v_xor_b32 v7, s34, v48
    v_bitop3_b32 v7, v49, s33, v7 bitop3:0xbe
    v_bitop3_b32 v7, v50, s40, v7 bitop3:0xbe
    v_bitop3_b32 v7, v51, s79, v7 bitop3:0xbe
    v_bitop3_b32 v7, v52, s34, v7 bitop3:0xbe
    v_bitop3_b32 v7, v53, s33, v7 bitop3:0xbe
    v_bitop3_b32 v7, v54, s40, v7 bitop3:0xbe
    v_bitop3_b32 v7, v55, s79, v7 bitop3:0xbe
    v_and_b32 v7, v4, v7
    v_cmp_ne_u32 vcc, 0, v7
    s_cbranch_vccz L_okY
    s_mov_b64 s[62:63], vcc
    s_mov_b64 exec, vcc
    buffer_load_dwordx4 v[48:51], v24, s[36:39], s72 offen sc1
    buffer_load_dwordx4 v[52:55], v25, s[36:39], s72 offen sc1
    s_mov_b64 exec, s[60:61]
    s_sub_u32 s43, s43, 1
    s_cbranch_scc0 L_op
    s_mov_b32 s43, 0
    s_waitcnt vmcnt(0)
L_okY:
    s_mov_b64 exec, -1
    v_and_b32 v56, 0xfffff800, v48
    v_and_b32 v57, 0xfffff800, v49
    v_and_b32 v58, 0xfffff800, v50
    v_and_b32 v59, 0xfffff800, v51
    v_and_b32 v60, 0xfffff800, v52
    v_and_b32 v61, 0xfffff800, v53
    v_and_b32 v62, 0xfffff800, v54
    v_and_b32 v63, 0xfffff800, v55
    s_branch L_oj
L_okX:
    s_mov_b64 exec, -1
    v_and_b32 v56, 0xfffff800, v32
    v_and_b32 v57, 0xfffff800, v33
    v_and_b32 v58, 0xfffff800, v34
    v_and_b32 v59, 0xfffff800, v35
    v_and_b32 v60, 0xfffff800, v36
    v_and_b32 v61, 0xfffff800, v37
    v_and_b32 v62, 0xfffff800, v38
    v_and_b32 v63, 0xfffff800, v39
L_oj:
    v_pk_mul_f32 v[56:57], v[56:57], v[40:41]
    v_pk_mul_f32 v[58:59], v[58:59], v[42:43]
    v_pk_fma_f32 v[56:57], v[60:61], v[44:45], v[56:57]
    v_pk_fma_f32 v[58:59], v[62:63], v[46:47], v[58:59]
    ds_read_b128 v[152:155], v1 offset:64
    ds_read_b64_tr_b16 v[64:65], v20 offset:0
    v_permlane32_swap_b32 v56, v57
    v_permlane32_swap_b32 v58, v59
    ds_read_b64_tr_b16 v[66:67], v20 offset:1024
    v_add_f32 v56, v56, v57
    v_add_f32 v58, v58, v59
    ds_read_b64_tr_b16 v[68:69], v20 offset:8192
    ds_read_b64_tr_b16 v[70:71], v20 offset:9216
    v_permlane16_swap_b32 v56, v58
    ds_read_b64_tr_b16 v[72:73], v21 offset:0
    v_add_f32 v56, v56, v58
    ds_read_b64_tr_b16 v[74:75], v21 offset:1024
    ds_read_b64_tr_b16 v[76:77], v21 offset:8192
    v_add_f32_dpp v56, v56, v56 row_ror:8 row_mask:0xf bank_mask:0xf
    ds_read_b64_tr_b16 v[78:79], v21 offset:9216

    v_cvt_pk_bf16_f32 v56, v56, v56
    ds_write_b16 v27, v56
    s_mov_b64 exec, 1
    ds_add_u32 v1, v30 offset:28
    s_mov_b64 exec, -1
    s_mov_b32 s56, 0x000f000f
    s_mov_b32 s57, 0x000f000f
    s_mov_b32 s59, 0x2000

L_sp_24:

    ds_read_b32 v6, v1 offset:28
    ds_read_b128 v[40:43], v28
    ds_read_b128 v[44:47], v28 offset:64
    s_waitcnt lgkmcnt(0)
    v_cmp_le_u32 vcc, 4, v6
    s_cbranch_vccz L_sp_24
    v_min3_i32 v152, v152, v153, v154
    v_min_i32 v152, v152, v155
    v_cmp_le_i32 vcc, s58, v152
    s_cbranch_vccz L_wolate
L_wook:
    v_mfma_f32_16x16x32_bf16 v[144:147], v[64:67], v[40:43], 0
    v_mfma_f32_16x16x32_bf16 v[148:151], v[72:75], v[40:43], 0
    v_mfma_f32_16x16x32_bf16 v[144:147], v[68:71], v[44:47], v[144:147]
    v_mfma_f32_16x16x32_bf16 v[148:151], v[76:79], v[44:47], v[148:151]
    s_mov_b64 exec, s[56:57]
    s_nop 6

    v_cndmask_b32 v144, v144, v148, s[52:53]
    v_cndmask_b32 v145, v145, v149, s[52:53]
    v_cndmask_b32 v146, v146, v150, s[52:53]
    v_cndmask_b32 v147, v147, v151, s[52:53]
    v_bfi_b32 v144, v4, s34, v144
    v_bfi_b32 v145, v4, s33, v145
    v_bfi_b32 v146, v4, s40, v146
    v_bfi_b32 v147, v4, s79, v147

    buffer_store_dwordx4 v[144:147], v23, s[36:39], 0 offen sc1

    s_waitcnt vmcnt(0)
    s_mov_b64 exec, 1
    ds_add_u32 v1, v30 offset:4
L_end:
    s_endpgm
L_wolate:
L_sl_25:

    ds_read_b128 v[160:163], v1 offset:64

    s_waitcnt lgkmcnt(0)
    v_min3_i32 v160, v160, v161, v162
    v_min_i32 v160, v160, v163
    v_cmp_le_i32 vcc, s58, v160
    s_cbranch_vccz L_sl_25
    ds_read_b64_tr_b16 v[64:65], v20 offset:0
    ds_read_b64_tr_b16 v[66:67], v20 offset:1024
    ds_read_b64_tr_b16 v[68:69], v20 offset:8192
    ds_read_b64_tr_b16 v[70:71], v20 offset:9216
    ds_read_b64_tr_b16 v[72:73], v21 offset:0
    ds_read_b64_tr_b16 v[74:75], v21 offset:1024
    ds_read_b64_tr_b16 v[76:77], v21 offset:8192
    ds_read_b64_tr_b16 v[78:79], v21 offset:9216
    s_waitcnt lgkmcnt(0)
    s_branch L_wook
L_codeend:
.section .rodata,"a"
.p2align 6
.amdhsa_kernel recurrent_scan__sliding_block_cached__dense_activation_squared_relu__decode_kernel
  .amdhsa_next_free_vgpr 168
  .amdhsa_next_free_sgpr 102
  .amdhsa_accum_offset 168
  .amdhsa_group_segment_fixed_size 0
  .amdhsa_kernarg_size 104
  .amdhsa_user_sgpr_count 2
  .amdhsa_user_sgpr_kernarg_segment_ptr 1
  .amdhsa_system_sgpr_workgroup_id_x 1
.end_amdhsa_kernel
```
